```python
import torch

def _softmax(x, axis=-1):
    return torch.softmax(x, dim=axis)

def _gelu(x):
    return torch.nn.functional.gelu(x, approximate='tanh')

def _silu(x):
    return torch.nn.functional.silu(x)

def _sigmoid(x):
    return torch.sigmoid(x)

def _layernorm(x, axis=-1, eps=1e-05):
    m = x.mean(dim=axis, keepdim=True)
    v = x.var(dim=axis, keepdim=True, unbiased=False)
    return (x - m) / torch.sqrt(v + eps)

def _scatter_add(tgt, idx, src, axis=0):
    return tgt.clone().index_add_(axis, idx, src)

def _segment_sum(src, seg, n):
    out = torch.zeros((n,) + src.shape[1:], dtype=src.dtype)
    return out.index_add_(0, seg, src)

def _pad(x, pw):
    flat = tuple((v for pair in reversed(pw) for v in pair))
    return torch.nn.functional.pad(x, flat)
kernel_name = 'standalone__autoregressive_conv_wavernn__speech'

def setup_inputs():

    _w = lambda a: (lambda t: t.to(torch.bfloat16) if t.is_floating_point() else t)(torch.as_tensor(a))
    B, T, D, K = (2, 1000, 256, 15)
    return {'x': _w((lambda *s: torch.randn(*s, dtype=torch.bfloat16) * 0.05)(B, T, D)), 'w': _w((lambda *s: torch.randn(*s, dtype=torch.bfloat16) * 0.05)(K, D, 2 * D))}

def reference(x, w):
    B, T, D = x.shape
    K = w.shape[0]
    dil = 2
    pad = (K - 1) * dil
    xp = _pad(x, ((0, 0), (pad, 0), (0, 0)))
    h = torch.einsum('btd,de->bte', xp[:, 0:T, :], w[0])
    for i in range(1, K):
        h = h + torch.einsum('btd,de->bte', xp[:, i * dil:i * dil + T, :], w[i])
    f, g = (h[..., :D].clone(), h[..., D:].clone())
    return torch.tanh(f) * _sigmoid(g)
```

```asm
; @launch grid=(256,1,1) block=(512,1,1) lds=157952
.amdgcn_target "amdgcn-amd-amdhsa--gfx950"
.text
.p2align 12
.globl standalone__autoregressive_conv_wavernn__speech_kernel
.p2align 8
.type standalone__autoregressive_conv_wavernn__speech_kernel,@function
standalone__autoregressive_conv_wavernn__speech_kernel:
    s_cmpk_ge_u32 s2, 256
    s_cbranch_scc1 L_end
    v_readfirstlane_b32 s3, v0
    s_bitcmp1_b32 s3, 8
    s_cbranch_scc1 L_compute
    s_load_dwordx4 s[16:19], s[0:1], 0
    s_lshr_b32 s7, s2, 5
    s_bfe_u32 s11, s2, 0x10001
    s_lshr_b32 s61, s3, 7
    s_lshl3_add_u32 s12, s7, s61
    s_lshr_b32 s3, s3, 6
    s_and_b32 s13, s3, 1
    s_lshl4_add_u32 s12, s12, s13
    s_sub_u32 s12, s12, 28
    s_lshl1_add_u32 s12, s12, s11
    s_lshl_b32 s12, s12, 8
    v_and_b32 v2, 56, v0
    v_lshlrev_b32 v2, 7, v2
    v_and_b32 v3, 7, v0
    v_lshlrev_b32 v3, 4, v3
    v_add3_u32 v8, v2, v3, s12
    s_mov_b32 s26, 512000
    s_mov_b32 s27, 0x20000
    s_bitcmp1_b32 s2, 4
    s_cselect_b32 s8, s26, 0
    s_mul_i32 s36, s3, 1056
    s_add_u32 s36, s36, 98304
    s_mov_b32 m0, s36
    s_movk_i32 s39, 0x4000
    s_waitcnt lgkmcnt(0)
    s_mov_b64 s[20:21], s[18:19]
    s_mov_b64 s[18:19], s[26:27]
    s_add_u32 s16, s16, s8
    s_addc_u32 s17, s17, 0
    buffer_load_dwordx4 v8, s[16:19], 0 offen offset:0 lds
    s_addk_i32 m0, 4224
    v_add_u32 v9, s39, v8
    buffer_load_dwordx4 v9, s[16:19], 0 offen offset:0 lds
    s_addk_i32 m0, 4224
    v_add_u32 v10, s39, v9
    buffer_load_dwordx4 v10, s[16:19], 0 offen offset:0 lds
    s_addk_i32 m0, 4224
    v_add_u32 v11, s39, v10
    buffer_load_dwordx4 v11, s[16:19], 0 offen offset:0 lds
    s_branch L_loader
L_compute:
    s_getpc_b64 s[46:47]
L_pc:
    v_and_b32 v0, 63, v0
    s_and_b32 s4, s2, 3
    s_lshr_b32 s3, s3, 6
    s_and_b32 s10, s3, 3
    s_lshr_b32 s12, s2, 3
    s_lshl2_add_u32 s12, s12, s10
    s_lshl_b32 s12, s12, 7
    s_and_b32 s5, s12, 0xf80
    s_lshl_b32 s13, s4, 13
    s_add_u32 s13, s13, s12
    s_add_u32 s13, s13, L_role0-L_pc
    s_bitcmp1_b32 s12, 13
    s_cselect_b32 s12, s5, s13
    s_add_u32 s46, s46, s12
    s_addc_u32 s47, s47, 0
    v_mov_b32 v14, s46
    v_mov_b32 v15, s47
    global_load_dword v16, v[14:15], off
    v_and_b32 v8, 15, v0
    v_lshrrev_b32 v9, 4, v0
    v_mul_u32_u24 v2, 1056, v8
    v_lshl_add_u32 v2, v9, 4, v2
    v_add_u32 v2, 98304, v2
    v_lshrrev_b32 v11, 3, v8
    v_and_b32 v12, 1, v9
    v_lshl_or_b32 v11, v12, 1, v11
    v_xor_b32 v11, s10, v11
    v_and_or_b32 v11, v8, 12, v11
    v_and_b32 v12, 3, v8
    v_lshl_add_u32 v11, v11, 2, v12
    v_mul_u32_u24 v1, 24576, v9
    v_lshl_add_u32 v1, v11, 3, v1
    s_mov_b64 exec, 0
    s_cmp_eq_u32 s10, 0
    s_cbranch_scc1 L_padL0
L_disp:
    s_cmp_eq_u32 s4, 1
    s_cbranch_scc1 L_role1
    s_cmp_eq_u32 s4, 2
    s_cbranch_scc1 L_role2
    s_cmp_eq_u32 s4, 3
    s_cbranch_scc1 L_role3
    s_branch L_role0
L_loader:
    v_and_b32 v0, 63, v0
    s_and_b32 s4, s2, 3
    s_bfe_u32 s6, s2, 0x20002
    s_lshl_b32 s13, s13, 6
    v_and_b32 v4, 16, v0
    v_lshlrev_b32 v4, 1, v4
    v_or_b32 v4, s13, v4
    v_xor_b32 v3, v3, v4
    s_and_b32 s14, s4, 1
    s_lshl2_add_u32 s14, s14, s6
    s_lshl_b32 s15, s11, 10
    s_add_u32 s15, s15, s14
    s_lshl_b32 s15, s15, 7
    s_lshl_b32 s12, s3, 13
    s_add_u32 s12, s12, s15
    v_add3_u32 v7, v2, v3, s12
    s_mul_i32 s37, s3, 24576
    s_mov_b32 s22, 3932160
    s_mov_b32 s23, s27
    s_add_u32 m0, s37, 0
    s_mov_b32 s38, 0
    buffer_load_dwordx4 v7, s[20:23], s38 offen offset:0 lds
    s_lshr_b32 s60, s2, 3
    s_lshl_b32 s60, s60, 10
    s_add_u32 s60, s60, s15
    s_lshl_b32 s13, s13, 2
    s_xor_b32 s60, s60, s13
    v_bfrev_b32 v19, 1
    s_add_u32 s12, s61, 1
    v_lshl_add_u32 v20, v0, 1, s12
    v_mul_u32_u24 v21, 4370, v20
    v_lshrrev_b32 v21, 16, v21
    v_mul_u32_u24 v21, 3899392, v21
    v_cmp_gt_u32 vcc, 23, v20
    v_lshl_add_u32 v20, v20, 18, s60
    v_sub_u32 v21, v20, v21
    v_cndmask_b32 v56, v19, v21, vcc
    buffer_load_dword v23, v56, s[20:23], 0 offen
    s_load_dwordx2 s[28:29], s[0:1], 32
    s_load_dwordx2 s[24:25], s[0:1], 16
    s_load_dwordx2 s[32:33], s[0:1], 24
    s_add_u32 m0, s36, 16896
    v_add_u32 v12, s39, v11
    buffer_load_dwordx4 v12, s[16:19], 0 offen offset:0 lds
    s_movk_i32 s51, 0x1000
    s_mov_b32 s52, 261120
    s_add_u32 s49, s52, s51
    s_add_u32 m0, s37, 0
    s_add_u32 s38, s38, s52
    buffer_load_dwordx4 v7, s[20:23], s38 offen offset:1024 lds
    s_add_u32 s38, s38, s52
    buffer_load_dwordx4 v7, s[20:23], s38 offen offset:2048 lds
    s_add_u32 s38, s38, s52
    buffer_load_dwordx4 v7, s[20:23], s38 offen offset:3072 lds
    s_addk_i32 m0, 4096
    s_add_u32 s38, s38, s49
    buffer_load_dwordx4 v7, s[20:23], s38 offen offset:0 lds
    s_lshr_b32 s9, s2, 2
    s_mov_b32 s30, 3162112
    s_mov_b32 s31, s27
    s_mul_i32 s48, s9, 49408
    s_waitcnt lgkmcnt(0)
    s_add_u32 s47, s48, 49152
    s_or_b32 s5, s3, s4
    s_cbranch_scc1 L_np0
    s_atomic_swap s5, s[28:29], s47 glc
L_np0:
    s_load_dword s54, s[28:29], s47 offset:128
    s_load_dwordx2 s[54:55], s[24:25], 60
    s_movk_i32 s34, 256
    s_mov_b32 s35, s27
    s_lshl_b32 s58, s9, 2
    s_xor_b32 s44, s4, 1
    s_mulk_i32 s44, 12288
    s_add_u32 s44, s44, s48
    s_xor_b32 s45, s4, 2
    s_mulk_i32 s45, 12288
    s_add_u32 s45, s45, s48
    s_addk_i32 s45, 4096
    s_xor_b32 s46, s4, 3
    s_mulk_i32 s46, 12288
    s_add_u32 s46, s46, s48
    s_addk_i32 s46, 8192
    s_lshl_b32 s12, s3, 10
    v_lshl_add_u32 v13, v0, 4, s12
    v_mov_b32 v24, -1
    v_mov_b32 v25, -1
    v_mov_b32 v26, -1
    v_mov_b32 v27, -1
    s_lshl3_add_u32 s53, s7, s14
    s_lshl2_add_u32 s53, s53, s3
    s_lshl3_add_u32 s53, s53, s11
    s_lshl_b32 s53, s53, 8
    s_mov_b32 s63, 0x80000
    s_movk_i32 s56, 0x400
    s_movk_i32 s57, 0x800
    s_movk_i32 s59, 0x2000
    s_lshl_b32 s12, s61, 14
    s_xor_b32 s60, s60, s12
    s_mov_b32 s62, 1
    s_mov_b32 s13, 0
    s_waitcnt vmcnt(6)
    s_barrier
    s_add_u32 s38, s38, s52
    buffer_load_dwordx4 v7, s[20:23], s38 offen offset:1024 lds
    s_add_u32 s38, s38, s52
    buffer_load_dwordx4 v7, s[20:23], s38 offen offset:2048 lds
    s_add_u32 s38, s38, s52
    buffer_load_dwordx4 v7, s[20:23], s38 offen offset:3072 lds
    s_or_b32 s12, s3, s4
    s_cbranch_scc1 L_np1
    s_waitcnt lgkmcnt(0)
    s_atomic_add s62, s[32:33], s58
L_np1:
    s_buffer_load_dwordx2 s[54:55], s[16:19], s53 offset:188
    s_buffer_load_dwordx2 s[54:55], s[16:19], s53 offset:700
    s_buffer_load_dwordx2 s[54:55], s[16:19], s53 offset:1212
    s_buffer_load_dwordx2 s[54:55], s[16:19], s53 offset:1724
    s_waitcnt vmcnt(6)
    s_barrier
    s_addk_i32 m0, 4096
    s_add_u32 s38, s38, s49
    buffer_load_dwordx4 v7, s[20:23], s38 offen offset:0 lds
    s_waitcnt vmcnt(6)
    s_barrier
    s_add_u32 s38, s38, s52
    buffer_load_dwordx4 v7, s[20:23], s38 offen offset:1024 lds
L_padL0:
    s_cbranch_execz L_padL1
    s_add_u32 s38, s38, s52
    buffer_load_dwordx4 v7, s[20:23], s38 offen offset:2048 lds
    s_waitcnt vmcnt(7)
    s_barrier
    s_add_u32 s38, s38, s52
    buffer_load_dwordx4 v7, s[20:23], s38 offen offset:3072 lds
    s_addk_i32 m0, 4096
    s_add_u32 s38, s38, s49
    buffer_load_dwordx4 v7, s[20:23], s38 offen offset:0 lds
    s_add_u32 s60, s60, 0x208000
    s_mul_i32 s12, s61, 0x40000
    s_add_u32 s60, s60, s12
    s_buffer_load_dwordx2 s[54:55], s[20:23], s60 offset:60
    s_waitcnt vmcnt(7)
    s_barrier
    s_add_u32 s38, s38, s52
    buffer_load_dwordx4 v7, s[20:23], s38 offen offset:1024 lds
    s_add_u32 s38, s38, s52
    buffer_load_dwordx4 v7, s[20:23], s38 offen offset:2048 lds
    s_mov_b32 s38, 29696
    buffer_load_dwordx4 v7, s[20:23], s38 offen offset:3072 lds
    s_add_u32 s60, s60, s63
    s_xor_b32 s60, s60, s56
    s_buffer_load_dwordx2 s[54:55], s[20:23], s60 offset:60
    s_waitcnt vmcnt(8)
    s_barrier
    s_addk_i32 m0, 4096
    s_add_u32 s38, s38, s49
    buffer_load_dwordx4 v7, s[20:23], s38 offen offset:0 lds
    s_add_u32 m0, s36, 20992
    s_nop 0
    buffer_load_dwordx4 v8, s[16:19], 0 offen offset:128 lds
    s_addk_i32 m0, 4224
    s_nop 0
    buffer_load_dwordx4 v9, s[16:19], 0 offen offset:128 lds
    s_addk_i32 m0, 4224
    s_nop 0
    buffer_load_dwordx4 v10, s[16:19], 0 offen offset:128 lds
    s_add_u32 s60, s60, s63
    s_xor_b32 s60, s60, s57
    s_buffer_load_dwordx2 s[54:55], s[20:23], s60 offset:60
    s_waitcnt vmcnt(10)
    s_barrier
    s_addk_i32 m0, 4224
    s_nop 0
    buffer_load_dwordx4 v11, s[16:19], 0 offen offset:128 lds
    s_addk_i32 m0, 4224
    s_nop 0
    buffer_load_dwordx4 v12, s[16:19], 0 offen offset:128 lds
    s_add_u32 s60, s60, s63
    s_mul_i32 s12, s61, 0xffc48000
    s_add_u32 s60, s60, s12
    s_xor_b32 s60, s60, s56
    s_buffer_load_dwordx2 s[54:55], s[20:23], s60 offset:60
    s_waitcnt vmcnt(10)
    s_barrier
    buffer_store_dwordx4 v[24:27], v13, s[28:31], s44 offen sc1
    s_add_u32 s60, s60, 0xffcc8000
    s_mul_i32 s12, s61, 0x3b8000
    s_add_u32 s60, s60, s12
    s_xor_b32 s60, s60, s51
    s_buffer_load_dwordx2 s[54:55], s[20:23], s60 offset:60
    s_waitcnt vmcnt(9)
    s_barrier
    buffer_store_dwordx4 v[24:27], v13, s[28:31], s45 offen sc1
    s_add_u32 s60, s60, s63
    s_xor_b32 s60, s60, s56
    s_buffer_load_dwordx2 s[54:55], s[20:23], s60 offset:60
    s_waitcnt vmcnt(8)
    s_barrier
    buffer_store_dwordx4 v[24:27], v13, s[28:31], s46 offen sc1
    buffer_load_dword v16, off, s[32:35], s58 sc1
    s_add_u32 m0, s37, 16384
    s_add_u32 s38, s38, s52
    buffer_load_dwordx4 v7, s[20:23], s38 offen offset:1024 lds
    s_add_u32 s38, s38, s52
    buffer_load_dwordx4 v7, s[20:23], s38 offen offset:2048 lds
    s_add_u32 s38, s38, s52
    buffer_load_dwordx4 v7, s[20:23], s38 offen offset:3072 lds
    s_add_u32 s60, s60, s63
    s_xor_b32 s60, s60, s57
    s_buffer_load_dwordx2 s[54:55], s[20:23], s60 offset:60
    s_waitcnt vmcnt(2)
    s_barrier
    s_addk_i32 m0, 4096
    s_add_u32 s38, s38, s49
    buffer_load_dwordx4 v7, s[20:23], s38 offen offset:0 lds
    s_add_u32 s38, s38, s52
    buffer_load_dwordx4 v7, s[20:23], s38 offen offset:1024 lds
    s_add_u32 s38, s38, s52
    buffer_load_dwordx4 v7, s[20:23], s38 offen offset:2048 lds
    s_add_u32 s60, s60, s63
    s_xor_b32 s60, s60, s56
    s_buffer_load_dwordx2 s[54:55], s[20:23], s60 offset:60
    s_waitcnt vmcnt(3)
    s_barrier
    s_add_u32 s38, s38, s52
    buffer_load_dwordx4 v7, s[20:23], s38 offen offset:3072 lds
    s_addk_i32 m0, -20480
    s_add_u32 s38, s38, s49
    buffer_load_dwordx4 v7, s[20:23], s38 offen offset:0 lds
    s_add_u32 s38, s38, s52
    buffer_load_dwordx4 v7, s[20:23], s38 offen offset:1024 lds
    s_add_u32 s38, s38, s52
    buffer_load_dwordx4 v7, s[20:23], s38 offen offset:2048 lds
    s_add_u32 s60, s60, s63
    s_xor_b32 s60, s60, s59
    s_buffer_load_dwordx2 s[54:55], s[20:23], s60 offset:60
    s_waitcnt vmcnt(5)
    s_barrier
    s_add_u32 s38, s38, s52
    buffer_load_dwordx4 v7, s[20:23], s38 offen offset:3072 lds
    s_addk_i32 m0, 4096
    s_add_u32 s38, s38, s49
    buffer_load_dwordx4 v7, s[20:23], s38 offen offset:0 lds
    s_add_u32 s38, s38, s52
    buffer_load_dwordx4 v7, s[20:23], s38 offen offset:1024 lds
    s_add_u32 s60, s60, s63
    s_xor_b32 s60, s60, s56
    s_buffer_load_dwordx2 s[54:55], s[20:23], s60 offset:60
    s_waitcnt vmcnt(6)
    s_barrier
    s_mov_b32 s38, 63488
    buffer_load_dwordx4 v7, s[20:23], s38 offen offset:2048 lds
    s_add_u32 s38, s38, s52
    buffer_load_dwordx4 v7, s[20:23], s38 offen offset:3072 lds
    s_add_u32 s60, s60, s63
    s_xor_b32 s60, s60, s57
    s_buffer_load_dwordx2 s[54:55], s[20:23], s60 offset:60
    s_cmp_lg_u32 s3, 0
    s_cbranch_scc1 L_noflag
    v_cmp_eq_u32 vcc, 0, v16
    s_cbranch_vccnz L_rdy
L_rdyok:
    s_atomic_add s62, s[28:29], s47
L_noflag:
    s_waitcnt vmcnt(6)
    s_barrier
    s_addk_i32 m0, 4096
    s_add_u32 s38, s38, s49
    buffer_load_dwordx4 v7, s[20:23], s38 offen offset:0 lds
    s_add_u32 s38, s38, s52
    buffer_load_dwordx4 v7, s[20:23], s38 offen offset:1024 lds
    s_add_u32 s38, s38, s52
    buffer_load_dwordx4 v7, s[20:23], s38 offen offset:2048 lds
    s_add_u32 s60, s60, 0xffcc8000
    s_xor_b32 s60, s60, s56
    s_buffer_load_dwordx2 s[54:55], s[20:23], s60 offset:60
    s_waitcnt vmcnt(7)
    s_barrier
    s_add_u32 s38, s38, s52
    buffer_load_dwordx4 v7, s[20:23], s38 offen offset:3072 lds
    s_addk_i32 m0, 4096
    s_add_u32 s38, s38, s49
    buffer_load_dwordx4 v7, s[20:23], s38 offen offset:0 lds
    s_add_u32 s38, s38, s52
    buffer_load_dwordx4 v7, s[20:23], s38 offen offset:1024 lds
    s_add_u32 s60, s60, s63
    s_xor_b32 s60, s60, s51
    s_buffer_load_dwordx2 s[54:55], s[20:23], s60 offset:60
    s_waitcnt vmcnt(8)
    s_barrier
    s_add_u32 s38, s38, s52
    buffer_load_dwordx4 v7, s[20:23], s38 offen offset:2048 lds
    s_add_u32 s38, s38, s52
    buffer_load_dwordx4 v7, s[20:23], s38 offen offset:3072 lds
    s_addk_i32 m0, 4096
    s_add_u32 s38, s38, s49
    buffer_load_dwordx4 v7, s[20:23], s38 offen offset:0 lds
    s_add_u32 s60, s60, s63
    s_xor_b32 s60, s60, s56
    s_buffer_load_dwordx2 s[54:55], s[20:23], s60 offset:60
    s_waitcnt vmcnt(9)
    s_barrier
    s_add_u32 s38, s38, s52
    buffer_load_dwordx4 v7, s[20:23], s38 offen offset:1024 lds
    s_add_u32 s38, s38, s52
    buffer_load_dwordx4 v7, s[20:23], s38 offen offset:2048 lds
    s_add_u32 s60, s60, s63
    s_xor_b32 s60, s60, s57
    s_buffer_load_dwordx2 s[54:55], s[20:23], s60 offset:60
    s_waitcnt vmcnt(9)
    s_barrier
    s_add_u32 s38, s38, s52
    buffer_load_dwordx4 v7, s[20:23], s38 offen offset:3072 lds
    s_addk_i32 m0, 4096
    s_add_u32 s38, s38, s49
    buffer_load_dwordx4 v7, s[20:23], s38 offen offset:0 lds
    s_mov_b32 s38, 97280
    buffer_load_dwordx4 v7, s[20:23], s38 offen offset:1024 lds
    s_add_u32 s60, s60, s63
    s_xor_b32 s60, s60, s56
    s_buffer_load_dwordx2 s[54:55], s[20:23], s60 offset:60
    s_waitcnt vmcnt(10)
    s_barrier
    s_add_u32 s38, s38, s52
    buffer_load_dwordx4 v7, s[20:23], s38 offen offset:2048 lds
    s_add_u32 s38, s38, s52
L_padL1:
    s_cbranch_execz L_disp
    buffer_load_dwordx4 v7, s[20:23], s38 offen offset:3072 lds
    s_addk_i32 m0, -20480
    s_add_u32 s38, s38, s49
    buffer_load_dwordx4 v7, s[20:23], s38 offen offset:0 lds
    s_add_u32 s60, s60, s63
    s_xor_b32 s60, s60, s39
    s_buffer_load_dwordx2 s[54:55], s[20:23], s60 offset:60
    s_waitcnt vmcnt(11)
    s_barrier
    s_add_u32 s38, s38, s52
    buffer_load_dwordx4 v7, s[20:23], s38 offen offset:1024 lds
    s_add_u32 s38, s38, s52
    buffer_load_dwordx4 v7, s[20:23], s38 offen offset:2048 lds
    s_add_u32 s38, s38, s52
    buffer_load_dwordx4 v7, s[20:23], s38 offen offset:3072 lds
    s_add_u32 s60, s60, s63
    s_xor_b32 s60, s60, s56
    s_buffer_load_dwordx2 s[54:55], s[20:23], s60 offset:60
    s_waitcnt vmcnt(12)
    s_barrier
    s_addk_i32 m0, 4096
    s_add_u32 s38, s38, s49
    buffer_load_dwordx4 v7, s[20:23], s38 offen offset:0 lds
    s_add_u32 s38, s38, s52
    buffer_load_dwordx4 v7, s[20:23], s38 offen offset:1024 lds
    s_add_u32 s60, s60, s63
    s_mul_i32 s12, s61, 0xfffc0000
    s_add_u32 s60, s60, s12
    s_xor_b32 s60, s60, s57
    s_buffer_load_dwordx2 s[54:55], s[20:23], s60 offset:60
    s_waitcnt vmcnt(12)
    s_barrier
    s_add_u32 s38, s38, s52
    buffer_load_dwordx4 v7, s[20:23], s38 offen offset:2048 lds
    s_add_u32 s38, s38, s52
    buffer_load_dwordx4 v7, s[20:23], s38 offen offset:3072 lds
    s_addk_i32 m0, 4096
    s_add_u32 s38, s38, s49
    buffer_load_dwordx4 v7, s[20:23], s38 offen offset:0 lds
    s_waitcnt vmcnt(13)
    s_barrier
    s_add_u32 s38, s38, s52
    buffer_load_dwordx4 v7, s[20:23], s38 offen offset:1024 lds
    s_add_u32 s38, s38, s52
    buffer_load_dwordx4 v7, s[20:23], s38 offen offset:2048 lds
    s_add_u32 s38, s38, s52
    buffer_load_dwordx4 v7, s[20:23], s38 offen offset:3072 lds
    s_waitcnt vmcnt(14)
    s_barrier
    buffer_load_dword v23, off, s[24:27], 0
    s_waitcnt vmcnt(13)
    s_barrier
    s_waitcnt vmcnt(11)
    s_barrier
    s_waitcnt vmcnt(9)
    s_barrier
    s_waitcnt vmcnt(7)
    s_barrier
    s_waitcnt vmcnt(5)
    s_barrier
    s_waitcnt vmcnt(3)
    s_barrier
    s_waitcnt vmcnt(1)
    s_barrier
    buffer_load_dword v16, off, s[28:31], s47 sc1
    s_mul_i32 s12, s4, 12288
    s_add_u32 s48, s48, s12
    s_add_u32 s50, s48, s59
    s_bitcmp1_b32 s4, 0
    s_mov_b32 s40, 0xbfb8aa3b
    s_cselect_b32 s40, 0x4038aa3b, s40
    s_mov_b32 s41, s40
    s_mov_b32 s43, 0xffff0000
    s_add_u32 s24, s24, s8
    s_addc_u32 s25, s25, 0
    v_and_b32 v20, 15, v0
    v_lshrrev_b32 v21, 4, v0
    v_mad_u32_u24 v14, v20, 17, v21
    s_lshl_b32 s12, s3, 6
    s_bitcmp0_b32 s4, 0
    s_cselect_b32 s42, 8704, 0
    s_add_u32 s12, s12, s42
    s_add_u32 s12, s12, 140544
    v_lshl_add_u32 v14, v14, 4, s12
    v_mad_u32_u24 v19, v21, 17, v20
    s_mul_i32 s12, s3, 1088
    s_add_u32 s12, s12, 140544
    v_lshl_add_u32 v19, v19, 4, s12
    v_mul_u32_u24 v21, 9, v21
    v_and_b32 v21, 17, v21
    s_lshl2_add_u32 s12, s7, s3
    s_lshl3_add_u32 s12, s12, s4
    s_lshl4_add_u32 s12, s12, s6
    s_lshl_b32 s12, s12, 7
    v_lshl_add_u32 v22, v21, 6, v20
    v_lshl_add_u32 v22, v22, 3, s12
    s_waitcnt vmcnt(0)
    v_cmp_gt_u32 vcc, 4, v16
    s_cbranch_vccnz L_flag
L_flagok:
    s_mov_b32 s13, 0
    s_barrier
    buffer_load_dwordx4 v[24:27], v13, s[28:31], s48 offen sc1
    buffer_load_dwordx4 v[28:31], v13, s[28:31], s50 offen sc1
L_poll:
    s_waitcnt vmcnt(0)
    v_max3_u32 v36, v24, v25, v26
    v_max3_u32 v37, v27, v28, v29
    v_max3_u32 v36, v36, v30, v31
    v_max_u32 v36, v36, v37
    v_cmp_eq_u32 vcc, -1, v36
    s_cbranch_vccnz L_repoll
L_got:
    v_lshlrev_b32 v40, 16, v24
    v_and_b32 v41, s43, v24
    v_lshlrev_b32 v48, 16, v28
    v_and_b32 v49, s43, v28
    v_lshlrev_b32 v42, 16, v25
    v_and_b32 v43, s43, v25
    v_lshlrev_b32 v50, 16, v29
    v_and_b32 v51, s43, v29
    v_add_f32 v40, v40, v48
    v_add_f32 v41, v41, v49
    v_add_f32 v42, v42, v50
    v_add_f32 v43, v43, v51
    v_mul_f32 v40, s40, v40
    v_mul_f32 v41, s40, v41
    v_mul_f32 v42, s40, v42
    v_mul_f32 v43, s40, v43
    v_exp_f32 v40, v40
    v_exp_f32 v41, v41
    v_exp_f32 v42, v42
    v_exp_f32 v43, v43
    v_add_f32 v40, 1.0, v40
    v_add_f32 v41, 1.0, v41
    v_add_f32 v42, 1.0, v42
    v_add_f32 v43, 1.0, v43
    v_rcp_f32 v40, v40
    v_rcp_f32 v41, v41
    v_rcp_f32 v42, v42
    v_rcp_f32 v43, v43
    s_nop 0
    ds_write_b128 v14, v[40:43] offset:0
    v_lshlrev_b32 v44, 16, v26
    v_and_b32 v45, s43, v26
    v_lshlrev_b32 v52, 16, v30
    v_and_b32 v53, s43, v30
    v_lshlrev_b32 v46, 16, v27
    v_and_b32 v47, s43, v27
    v_lshlrev_b32 v54, 16, v31
    v_and_b32 v55, s43, v31
    v_pk_add_f32 v[44:45], v[44:45], v[52:53]
    v_pk_add_f32 v[46:47], v[46:47], v[54:55]
    v_pk_mul_f32 v[44:45], v[44:45], s[40:41]
    v_pk_mul_f32 v[46:47], v[46:47], s[40:41]
    v_exp_f32 v44, v44
    v_exp_f32 v45, v45
    v_exp_f32 v46, v46
    v_exp_f32 v47, v47
    v_pk_add_f32 v[44:45], v[44:45], 1.0 op_sel_hi:[1,0]
    v_pk_add_f32 v[46:47], v[46:47], 1.0 op_sel_hi:[1,0]
    v_rcp_f32 v44, v44
    v_rcp_f32 v45, v45
    v_rcp_f32 v46, v46
    v_rcp_f32 v47, v47
    s_nop 0
    ds_write_b128 v14, v[44:47] offset:4352
    s_waitcnt lgkmcnt(0)
    s_barrier
    ds_read_b128 v[24:27], v19
    ds_read_b128 v[28:31], v19 offset:8704
    s_waitcnt lgkmcnt(0)
    v_pk_mul_f32 v[24:25], v[24:25], v[28:29]
    v_pk_mul_f32 v[26:27], v[26:27], v[30:31]
    v_pk_fma_f32 v[24:25], v[24:25], -2.0, v[28:29] op_sel_hi:[1,0,1]
    v_pk_fma_f32 v[26:27], v[26:27], -2.0, v[30:31] op_sel_hi:[1,0,1]
    v_cvt_pk_bf16_f32 v24, v24, v25
    v_cvt_pk_bf16_f32 v25, v26, v27
    buffer_store_dwordx2 v[24:25], v22, s[24:27], 0 offen
L_end:
    s_endpgm
L_repoll:
    s_add_u32 s13, s13, 1
    s_cmp_ge_u32 s13, 200000
    s_cbranch_scc1 L_got
    buffer_load_dwordx4 v[24:27], v13, s[28:31], s48 offen sc1
    buffer_load_dwordx4 v[28:31], v13, s[28:31], s50 offen sc1
    s_branch L_poll
L_flag:
    s_add_u32 s13, s13, 1
    s_cmp_ge_u32 s13, 200000
    s_cbranch_scc1 L_flagok
    buffer_load_dword v16, off, s[28:31], s47 sc1
    s_waitcnt vmcnt(0)
    v_cmp_gt_u32 vcc, 4, v16
    s_cbranch_vccnz L_flag
    s_branch L_flagok
L_rdy:
    s_add_u32 s13, s13, 1
    s_cmp_ge_u32 s13, 200000
    s_cbranch_scc1 L_rdyok
    buffer_load_dword v16, off, s[32:35], s58 sc1
    s_waitcnt vmcnt(0)
    v_cmp_eq_u32 vcc, 0, v16
    s_cbranch_vccnz L_rdy
    s_branch L_rdyok
.p2align 12
L_role0:
    s_load_dwordx2 s[28:29], s[0:1], 32
    s_load_dwordx2 s[24:25], s[0:1], 16
    s_cmp_eq_u32 s10, 1
    s_cbranch_scc1 L_pad0_0
    s_cmp_eq_u32 s10, 2
    s_cbranch_scc1 L_pad0_1
    s_cmp_eq_u32 s10, 3
    s_cbranch_scc1 L_pad0_2
L_main0:
    s_mov_b64 exec, -1
    s_setprio 1
    s_waitcnt vmcnt(0) lgkmcnt(0)
    s_barrier
    ds_read_b64_tr_b16 v[36:37], v1 offset:0
    ds_read_b64_tr_b16 v[38:39], v1 offset:512
    ds_read_b128 v[40:43], v2 offset:0
    ds_read_b128 v[44:47], v2 offset:128
    ds_read_b128 v[48:51], v2 offset:256
    ds_read_b128 v[52:55], v2 offset:384
    ds_read_b128 v[56:59], v2 offset:512
    ds_read_b128 v[60:63], v2 offset:640
    s_waitcnt lgkmcnt(5)
    v_mfma_f32_16x16x32_bf16 v[4:7], v[36:39], v[40:43], 0
    s_waitcnt lgkmcnt(4)
    ds_read_b128 v[64:67], v2 offset:768
    v_mfma_f32_16x16x32_bf16 v[8:11], v[36:39], v[44:47], 0
    s_waitcnt lgkmcnt(4)
    ds_read_b128 v[68:71], v2 offset:896
    v_mfma_f32_16x16x32_bf16 v[12:15], v[36:39], v[48:51], 0
    s_waitcnt lgkmcnt(4)
    v_mfma_f32_16x16x32_bf16 v[16:19], v[36:39], v[52:55], 0
    s_waitcnt lgkmcnt(3)
    s_barrier
    ds_read_b64_tr_b16 v[72:73], v1 offset:1024
    v_mfma_f32_16x16x32_bf16 v[20:23], v[36:39], v[56:59], 0
    s_waitcnt lgkmcnt(3)
    ds_read_b64_tr_b16 v[74:75], v1 offset:1536
    v_mfma_f32_16x16x32_bf16 v[24:27], v[36:39], v[60:63], 0
    s_waitcnt lgkmcnt(3)
    ds_read_b128 v[76:79], v2 offset:2112
    v_mfma_f32_16x16x32_bf16 v[28:31], v[36:39], v[64:67], 0
    s_waitcnt lgkmcnt(3)
    s_barrier
    v_mfma_f32_16x16x32_bf16 v[32:35], v[36:39], v[68:71], 0
    s_waitcnt lgkmcnt(1)
    ds_read_b64_tr_b16 v[80:81], v1 offset:2048
    v_mfma_f32_16x16x32_bf16 v[4:7], v[72:75], v[44:47], v[4:7]
    ds_read_b64_tr_b16 v[82:83], v1 offset:2560
    v_mfma_f32_16x16x32_bf16 v[8:11], v[72:75], v[48:51], v[8:11]
    v_mfma_f32_16x16x32_bf16 v[12:15], v[72:75], v[52:55], v[12:15]
    v_mfma_f32_16x16x32_bf16 v[16:19], v[72:75], v[56:59], v[16:19]
    v_mfma_f32_16x16x32_bf16 v[20:23], v[72:75], v[60:63], v[20:23]
    v_mfma_f32_16x16x32_bf16 v[24:27], v[72:75], v[64:67], v[24:27]
    s_lshr_b32 s9, s2, 2
    ds_read_b128 v[84:87], v2 offset:2240
    s_and_b32 s6, s9, 3
    v_mfma_f32_16x16x32_bf16 v[28:31], v[72:75], v[68:71], v[28:31]
    s_waitcnt lgkmcnt(1)
    s_barrier
    v_mfma_f32_16x16x32_bf16 v[32:35], v[72:75], v[76:79], v[32:35]
    s_lshr_b32 s7, s2, 5
    ds_read_b64_tr_b16 v[88:89], v1 offset:3072
    s_mov_b32 s26, 512000
    v_mfma_f32_16x16x32_bf16 v[4:7], v[80:83], v[48:51], v[4:7]
    s_mov_b32 s27, 0x20000
    ds_read_b64_tr_b16 v[90:91], v1 offset:3584
    s_bitcmp1_b32 s2, 4
    v_mfma_f32_16x16x32_bf16 v[8:11], v[80:83], v[52:55], v[8:11]
    s_cselect_b32 s8, s26, 0
    s_mov_b32 s30, 3162112
    s_mov_b32 s31, s27
    v_mfma_f32_16x16x32_bf16 v[12:15], v[80:83], v[56:59], v[12:15]
    s_lshl_b32 s12, s10, 10
    v_lshl_add_u32 v3, v0, 4, s12
    s_mul_i32 s12, s9, 49408
    v_mfma_f32_16x16x32_bf16 v[16:19], v[80:83], v[60:63], v[16:19]
    s_add_u32 s41, s12, 12288
    s_add_u32 s42, s12, 28672
    s_add_u32 s43, s12, 45056
    v_mfma_f32_16x16x32_bf16 v[20:23], v[80:83], v[64:67], v[20:23]
    s_add_u32 s44, s12, 4096
    ds_read_b128 v[92:95], v2 offset:2368
    s_mov_b32 s13, 0
    v_mfma_f32_16x16x32_bf16 v[24:27], v[80:83], v[68:71], v[24:27]
    s_barrier
    s_mov_b32 s38, 0xffff0000
    v_mfma_f32_16x16x32_bf16 v[28:31], v[80:83], v[76:79], v[28:31]
    s_waitcnt lgkmcnt(1)
    ds_read_b64_tr_b16 v[96:97], v1 offset:4096
    s_mov_b32 s36, 0x4038aa3b
    v_mfma_f32_16x16x32_bf16 v[32:35], v[80:83], v[84:87], v[32:35]
    s_mov_b32 s37, s36
    ds_read_b64_tr_b16 v[98:99], v1 offset:4608
    s_add_u32 s24, s24, s8
    v_mfma_f32_16x16x32_bf16 v[4:7], v[88:91], v[52:55], v[4:7]
    s_addc_u32 s25, s25, 0
    ds_read_b64_tr_b16 v[100:101], v1 offset:5120
    v_mfma_f32_16x16x32_bf16 v[8:11], v[88:91], v[56:59], v[8:11]
    ds_read_b64_tr_b16 v[102:103], v1 offset:5632
    v_mfma_f32_16x16x32_bf16 v[12:15], v[88:91], v[60:63], v[12:15]
    v_mfma_f32_16x16x32_bf16 v[16:19], v[88:91], v[64:67], v[16:19]
    v_mfma_f32_16x16x32_bf16 v[20:23], v[88:91], v[68:71], v[20:23]
    v_mfma_f32_16x16x32_bf16 v[24:27], v[88:91], v[76:79], v[24:27]
    v_mfma_f32_16x16x32_bf16 v[28:31], v[88:91], v[84:87], v[28:31]
    s_waitcnt lgkmcnt(0)
    v_mfma_f32_16x16x32_bf16 v[32:35], v[88:91], v[92:95], v[32:35]
    v_mfma_f32_16x16x32_bf16 v[4:7], v[96:99], v[56:59], v[4:7]
    v_mfma_f32_16x16x32_bf16 v[4:7], v[100:103], v[60:63], v[4:7]
    v_mfma_f32_16x16x32_bf16 v[8:11], v[96:99], v[60:63], v[8:11]
    v_mfma_f32_16x16x32_bf16 v[8:11], v[100:103], v[64:67], v[8:11]
    ds_read_b128 v[104:107], v2 offset:2496
    v_mfma_f32_16x16x32_bf16 v[12:15], v[96:99], v[64:67], v[12:15]
    ds_read_b128 v[108:111], v2 offset:2624
    v_mfma_f32_16x16x32_bf16 v[12:15], v[100:103], v[68:71], v[12:15]
    s_barrier
    v_mfma_f32_16x16x32_bf16 v[16:19], v[96:99], v[68:71], v[16:19]
    ds_read_b64_tr_b16 v[112:113], v1 offset:6144
    v_mfma_f32_16x16x32_bf16 v[16:19], v[100:103], v[76:79], v[16:19]
    ds_read_b64_tr_b16 v[114:115], v1 offset:6656
    v_mfma_f32_16x16x32_bf16 v[20:23], v[96:99], v[76:79], v[20:23]
    ds_read_b64_tr_b16 v[116:117], v1 offset:7168
    v_mfma_f32_16x16x32_bf16 v[20:23], v[100:103], v[84:87], v[20:23]
    ds_read_b64_tr_b16 v[118:119], v1 offset:7680
    v_mfma_f32_16x16x32_bf16 v[24:27], v[96:99], v[84:87], v[24:27]
    v_mfma_f32_16x16x32_bf16 v[24:27], v[100:103], v[92:95], v[24:27]
    v_mfma_f32_16x16x32_bf16 v[28:31], v[96:99], v[92:95], v[28:31]
    s_waitcnt lgkmcnt(2)
    v_mfma_f32_16x16x32_bf16 v[28:31], v[100:103], v[104:107], v[28:31]
    v_mfma_f32_16x16x32_bf16 v[32:35], v[96:99], v[104:107], v[32:35]
    v_mfma_f32_16x16x32_bf16 v[32:35], v[100:103], v[108:111], v[32:35]
    v_mfma_f32_16x16x32_bf16 v[4:7], v[112:115], v[64:67], v[4:7]
    s_waitcnt lgkmcnt(0)
    v_mfma_f32_16x16x32_bf16 v[4:7], v[116:119], v[68:71], v[4:7]
    v_mfma_f32_16x16x32_bf16 v[8:11], v[112:115], v[68:71], v[8:11]
    v_mfma_f32_16x16x32_bf16 v[8:11], v[116:119], v[76:79], v[8:11]
    ds_read_b128 v[120:123], v2 offset:2752
    v_mfma_f32_16x16x32_bf16 v[12:15], v[112:115], v[76:79], v[12:15]
    ds_read_b128 v[124:127], v2 offset:2880
    v_mfma_f32_16x16x32_bf16 v[12:15], v[116:119], v[84:87], v[12:15]
    s_barrier
    v_mfma_f32_16x16x32_bf16 v[16:19], v[112:115], v[84:87], v[16:19]
    ds_read_b64_tr_b16 v[128:129], v1 offset:8192
    v_mfma_f32_16x16x32_bf16 v[16:19], v[116:119], v[92:95], v[16:19]
    ds_read_b64_tr_b16 v[130:131], v1 offset:8704
    v_mfma_f32_16x16x32_bf16 v[20:23], v[112:115], v[92:95], v[20:23]
    ds_read_b64_tr_b16 v[132:133], v1 offset:9216
    v_mfma_f32_16x16x32_bf16 v[20:23], v[116:119], v[104:107], v[20:23]
    ds_read_b64_tr_b16 v[134:135], v1 offset:9728
    v_mfma_f32_16x16x32_bf16 v[24:27], v[112:115], v[104:107], v[24:27]
    v_mfma_f32_16x16x32_bf16 v[24:27], v[116:119], v[108:111], v[24:27]
L_pad0_0:
    s_cbranch_execz L_pad0_3
    v_mfma_f32_16x16x32_bf16 v[28:31], v[112:115], v[108:111], v[28:31]
    s_waitcnt lgkmcnt(2)
    v_mfma_f32_16x16x32_bf16 v[28:31], v[116:119], v[120:123], v[28:31]
    v_mfma_f32_16x16x32_bf16 v[32:35], v[112:115], v[120:123], v[32:35]
    v_mfma_f32_16x16x32_bf16 v[32:35], v[116:119], v[124:127], v[32:35]
    v_mfma_f32_16x16x32_bf16 v[4:7], v[128:131], v[76:79], v[4:7]
    s_waitcnt lgkmcnt(0)
    v_mfma_f32_16x16x32_bf16 v[4:7], v[132:135], v[84:87], v[4:7]
    v_mfma_f32_16x16x32_bf16 v[8:11], v[128:131], v[84:87], v[8:11]
    v_mfma_f32_16x16x32_bf16 v[8:11], v[132:135], v[92:95], v[8:11]
    ds_read_b128 v[136:139], v2 offset:3008
    v_mfma_f32_16x16x32_bf16 v[12:15], v[128:131], v[92:95], v[12:15]
    ds_read_b128 v[140:143], v2 offset:4224
    v_mfma_f32_16x16x32_bf16 v[12:15], v[132:135], v[104:107], v[12:15]
    s_barrier
    v_mfma_f32_16x16x32_bf16 v[16:19], v[128:131], v[104:107], v[16:19]
    ds_read_b64_tr_b16 v[144:145], v1 offset:10240
    v_mfma_f32_16x16x32_bf16 v[16:19], v[132:135], v[108:111], v[16:19]
    ds_read_b64_tr_b16 v[146:147], v1 offset:10752
    v_mfma_f32_16x16x32_bf16 v[20:23], v[128:131], v[108:111], v[20:23]
    ds_read_b64_tr_b16 v[148:149], v1 offset:11264
    v_mfma_f32_16x16x32_bf16 v[20:23], v[132:135], v[120:123], v[20:23]
    ds_read_b64_tr_b16 v[150:151], v1 offset:11776
    v_mfma_f32_16x16x32_bf16 v[24:27], v[128:131], v[120:123], v[24:27]
    v_mfma_f32_16x16x32_bf16 v[24:27], v[132:135], v[124:127], v[24:27]
    v_mfma_f32_16x16x32_bf16 v[28:31], v[128:131], v[124:127], v[28:31]
    s_waitcnt lgkmcnt(2)
    v_mfma_f32_16x16x32_bf16 v[28:31], v[132:135], v[136:139], v[28:31]
    v_mfma_f32_16x16x32_bf16 v[32:35], v[128:131], v[136:139], v[32:35]
    v_mfma_f32_16x16x32_bf16 v[32:35], v[132:135], v[140:143], v[32:35]
    v_mfma_f32_16x16x32_bf16 v[4:7], v[144:147], v[92:95], v[4:7]
    s_waitcnt lgkmcnt(0)
    v_mfma_f32_16x16x32_bf16 v[4:7], v[148:151], v[104:107], v[4:7]
    v_mfma_f32_16x16x32_bf16 v[8:11], v[144:147], v[104:107], v[8:11]
    v_mfma_f32_16x16x32_bf16 v[8:11], v[148:151], v[108:111], v[8:11]
    ds_read_b128 v[152:155], v2 offset:4352
    v_mfma_f32_16x16x32_bf16 v[12:15], v[144:147], v[108:111], v[12:15]
    ds_read_b128 v[156:159], v2 offset:4480
    v_mfma_f32_16x16x32_bf16 v[12:15], v[148:151], v[120:123], v[12:15]
    s_barrier
    v_mfma_f32_16x16x32_bf16 v[16:19], v[144:147], v[120:123], v[16:19]
    ds_read_b64_tr_b16 v[160:161], v1 offset:12288
    v_mfma_f32_16x16x32_bf16 v[16:19], v[148:151], v[124:127], v[16:19]
    ds_read_b64_tr_b16 v[162:163], v1 offset:12800
    v_mfma_f32_16x16x32_bf16 v[20:23], v[144:147], v[124:127], v[20:23]
    ds_read_b64_tr_b16 v[164:165], v1 offset:13312
    v_mfma_f32_16x16x32_bf16 v[20:23], v[148:151], v[136:139], v[20:23]
    ds_read_b64_tr_b16 v[166:167], v1 offset:13824
    v_mfma_f32_16x16x32_bf16 v[24:27], v[144:147], v[136:139], v[24:27]
    v_mfma_f32_16x16x32_bf16 v[24:27], v[148:151], v[140:143], v[24:27]
    v_mfma_f32_16x16x32_bf16 v[28:31], v[144:147], v[140:143], v[28:31]
    s_waitcnt lgkmcnt(2)
    v_mfma_f32_16x16x32_bf16 v[28:31], v[148:151], v[152:155], v[28:31]
    v_mfma_f32_16x16x32_bf16 v[32:35], v[144:147], v[152:155], v[32:35]
    v_mfma_f32_16x16x32_bf16 v[32:35], v[148:151], v[156:159], v[32:35]
    v_mfma_f32_16x16x32_bf16 v[4:7], v[160:163], v[108:111], v[4:7]
    s_waitcnt lgkmcnt(0)
    v_mfma_f32_16x16x32_bf16 v[4:7], v[164:167], v[120:123], v[4:7]
    v_mfma_f32_16x16x32_bf16 v[8:11], v[160:163], v[120:123], v[8:11]
    ds_read_b128 v[168:171], v2 offset:4608
    v_mfma_f32_16x16x32_bf16 v[8:11], v[164:167], v[124:127], v[8:11]
    ds_read_b128 v[172:175], v2 offset:4736
    v_mfma_f32_16x16x32_bf16 v[12:15], v[160:163], v[124:127], v[12:15]
    ds_read_b128 v[176:179], v2 offset:64
    v_mfma_f32_16x16x32_bf16 v[12:15], v[164:167], v[136:139], v[12:15]
    s_barrier
    v_mfma_f32_16x16x32_bf16 v[16:19], v[160:163], v[136:139], v[16:19]
    ds_read_b64_tr_b16 v[180:181], v1 offset:14336
    v_mfma_f32_16x16x32_bf16 v[16:19], v[164:167], v[140:143], v[16:19]
    ds_read_b64_tr_b16 v[182:183], v1 offset:14848
    v_mfma_f32_16x16x32_bf16 v[20:23], v[160:163], v[140:143], v[20:23]
    ds_read_b64_tr_b16 v[184:185], v1 offset:15360
    v_mfma_f32_16x16x32_bf16 v[20:23], v[164:167], v[152:155], v[20:23]
    ds_read_b64_tr_b16 v[186:187], v1 offset:15872
    v_mfma_f32_16x16x32_bf16 v[24:27], v[160:163], v[152:155], v[24:27]
    v_mfma_f32_16x16x32_bf16 v[24:27], v[164:167], v[156:159], v[24:27]
    ds_read_b128 v[188:191], v2 offset:192
    v_mfma_f32_16x16x32_bf16 v[28:31], v[160:163], v[156:159], v[28:31]
    s_waitcnt lgkmcnt(3)
    ds_read_b128 v[192:195], v2 offset:320
    v_mfma_f32_16x16x32_bf16 v[28:31], v[164:167], v[168:171], v[28:31]
    v_mfma_f32_16x16x32_bf16 v[32:35], v[160:163], v[168:171], v[32:35]
    ds_read_b128 v[196:199], v2 offset:448
    v_mfma_f32_16x16x32_bf16 v[32:35], v[164:167], v[172:175], v[32:35]
    ds_read_b128 v[200:203], v2 offset:576
    v_mfma_f32_16x16x32_bf16 v[4:7], v[180:183], v[124:127], v[4:7]
    s_waitcnt lgkmcnt(3)
    ds_read_b128 v[204:207], v2 offset:704
    v_mfma_f32_16x16x32_bf16 v[4:7], v[184:187], v[176:179], v[4:7]
    v_mfma_f32_16x16x32_bf16 v[8:11], v[180:183], v[136:139], v[8:11]
    ds_read_b128 v[208:211], v2 offset:832
    v_mfma_f32_16x16x32_bf16 v[8:11], v[184:187], v[188:191], v[8:11]
    ds_read_b128 v[212:215], v2 offset:4864
    v_mfma_f32_16x16x32_bf16 v[12:15], v[180:183], v[140:143], v[12:15]
    s_waitcnt lgkmcnt(3)
    ds_read_b128 v[216:219], v2 offset:960
    v_mfma_f32_16x16x32_bf16 v[12:15], v[184:187], v[192:195], v[12:15]
    s_barrier
    v_mfma_f32_16x16x32_bf16 v[16:19], v[180:183], v[152:155], v[16:19]
    ds_read_b64_tr_b16 v[220:221], v1 offset:16384
    v_mfma_f32_16x16x32_bf16 v[16:19], v[184:187], v[196:199], v[16:19]
    ds_read_b64_tr_b16 v[222:223], v1 offset:16896
    v_mfma_f32_16x16x32_bf16 v[20:23], v[180:183], v[156:159], v[20:23]
    ds_read_b64_tr_b16 v[224:225], v1 offset:17408
    v_mfma_f32_16x16x32_bf16 v[20:23], v[184:187], v[200:203], v[20:23]
    ds_read_b64_tr_b16 v[226:227], v1 offset:17920
    v_mfma_f32_16x16x32_bf16 v[24:27], v[180:183], v[168:171], v[24:27]
    s_waitcnt lgkmcnt(4)
    v_mfma_f32_16x16x32_bf16 v[24:27], v[184:187], v[204:207], v[24:27]
    v_mfma_f32_16x16x32_bf16 v[28:31], v[180:183], v[172:175], v[28:31]
    v_mfma_f32_16x16x32_bf16 v[28:31], v[184:187], v[208:211], v[28:31]
    v_mfma_f32_16x16x32_bf16 v[32:35], v[180:183], v[212:215], v[32:35]
    v_mfma_f32_16x16x32_bf16 v[32:35], v[184:187], v[216:219], v[32:35]
    s_waitcnt lgkmcnt(0)
    ds_read_b128 v[228:231], v2 offset:2176
    v_mfma_f32_16x16x32_bf16 v[12:15], v[220:223], v[196:199], v[12:15]
    ds_read_b128 v[232:235], v2 offset:2304
    v_mfma_f32_16x16x32_bf16 v[12:15], v[224:227], v[200:203], v[12:15]
    s_barrier
    v_mfma_f32_16x16x32_bf16 v[16:19], v[220:223], v[200:203], v[16:19]
    ds_read_b64_tr_b16 v[236:237], v1 offset:18432
    v_mfma_f32_16x16x32_bf16 v[16:19], v[224:227], v[204:207], v[16:19]
    ds_read_b64_tr_b16 v[238:239], v1 offset:18944
    v_mfma_f32_16x16x32_bf16 v[20:23], v[220:223], v[204:207], v[20:23]
    ds_read_b64_tr_b16 v[240:241], v1 offset:19456
    v_mfma_f32_16x16x32_bf16 v[20:23], v[224:227], v[208:211], v[20:23]
    ds_read_b64_tr_b16 v[242:243], v1 offset:19968
    v_mfma_f32_16x16x32_bf16 v[24:27], v[220:223], v[208:211], v[24:27]
    v_mfma_f32_16x16x32_bf16 v[24:27], v[224:227], v[216:219], v[24:27]
    v_mfma_f32_16x16x32_bf16 v[28:31], v[220:223], v[216:219], v[28:31]
    s_waitcnt lgkmcnt(2)
    v_mfma_f32_16x16x32_bf16 v[28:31], v[224:227], v[228:231], v[28:31]
    v_mfma_f32_16x16x32_bf16 v[32:35], v[220:223], v[228:231], v[32:35]
    v_mfma_f32_16x16x32_bf16 v[32:35], v[224:227], v[232:235], v[32:35]
    ds_read_b128 v[244:247], v2 offset:2432
    v_mfma_f32_16x16x32_bf16 v[12:15], v[236:239], v[204:207], v[12:15]
    s_waitcnt lgkmcnt(1)
    ds_read_b128 v[248:251], v2 offset:2560
    v_mfma_f32_16x16x32_bf16 v[12:15], v[240:243], v[208:211], v[12:15]
    s_barrier
    v_mfma_f32_16x16x32_bf16 v[16:19], v[236:239], v[208:211], v[16:19]
    ds_read_b64_tr_b16 v[252:253], v1 offset:20480
    v_mfma_f32_16x16x32_bf16 v[16:19], v[240:243], v[216:219], v[16:19]
L_pad0_1:
    s_cbranch_execz L_pad0_4
    ds_read_b64_tr_b16 v[254:255], v1 offset:20992
    v_mfma_f32_16x16x32_bf16 v[20:23], v[236:239], v[216:219], v[20:23]
    ds_read_b64_tr_b16 v[40:41], v1 offset:21504
    v_mfma_f32_16x16x32_bf16 v[20:23], v[240:243], v[228:231], v[20:23]
    ds_read_b64_tr_b16 v[42:43], v1 offset:22016
    v_mfma_f32_16x16x32_bf16 v[24:27], v[236:239], v[228:231], v[24:27]
    v_mfma_f32_16x16x32_bf16 v[24:27], v[240:243], v[232:235], v[24:27]
    v_mfma_f32_16x16x32_bf16 v[28:31], v[236:239], v[232:235], v[28:31]
    s_waitcnt lgkmcnt(2)
    v_mfma_f32_16x16x32_bf16 v[28:31], v[240:243], v[244:247], v[28:31]
    v_mfma_f32_16x16x32_bf16 v[32:35], v[236:239], v[244:247], v[32:35]
    v_mfma_f32_16x16x32_bf16 v[32:35], v[240:243], v[248:251], v[32:35]
    ds_read_b128 v[36:39], v2 offset:2688
    v_mfma_f32_16x16x32_bf16 v[12:15], v[252:255], v[216:219], v[12:15]
    s_waitcnt lgkmcnt(1)
    ds_read_b128 v[44:47], v2 offset:2816
    v_mfma_f32_16x16x32_bf16 v[12:15], v[40:43], v[228:231], v[12:15]
    s_barrier
    v_mfma_f32_16x16x32_bf16 v[16:19], v[252:255], v[228:231], v[16:19]
    ds_read_b64_tr_b16 v[72:73], v1 offset:22528
    v_mfma_f32_16x16x32_bf16 v[16:19], v[40:43], v[232:235], v[16:19]
    ds_read_b64_tr_b16 v[74:75], v1 offset:23040
    v_mfma_f32_16x16x32_bf16 v[20:23], v[252:255], v[232:235], v[20:23]
    ds_read_b64_tr_b16 v[48:49], v1 offset:23552
    v_mfma_f32_16x16x32_bf16 v[20:23], v[40:43], v[244:247], v[20:23]
    ds_read_b64_tr_b16 v[50:51], v1 offset:24064
    v_mfma_f32_16x16x32_bf16 v[24:27], v[252:255], v[244:247], v[24:27]
    v_mfma_f32_16x16x32_bf16 v[24:27], v[40:43], v[248:251], v[24:27]
    v_mfma_f32_16x16x32_bf16 v[28:31], v[252:255], v[248:251], v[28:31]
    s_waitcnt lgkmcnt(2)
    v_mfma_f32_16x16x32_bf16 v[28:31], v[40:43], v[36:39], v[28:31]
    v_mfma_f32_16x16x32_bf16 v[32:35], v[252:255], v[36:39], v[32:35]
    v_mfma_f32_16x16x32_bf16 v[32:35], v[40:43], v[44:47], v[32:35]
    ds_read_b128 v[80:83], v2 offset:2944
    v_mfma_f32_16x16x32_bf16 v[12:15], v[72:75], v[232:235], v[12:15]
    s_waitcnt lgkmcnt(1)
    ds_read_b128 v[52:55], v2 offset:3072
    v_mfma_f32_16x16x32_bf16 v[12:15], v[48:51], v[244:247], v[12:15]
    s_barrier
    v_mfma_f32_16x16x32_bf16 v[16:19], v[72:75], v[244:247], v[16:19]
    ds_read_b64_tr_b16 v[88:89], v1 offset:0
    v_mfma_f32_16x16x32_bf16 v[16:19], v[48:51], v[248:251], v[16:19]
    ds_read_b64_tr_b16 v[90:91], v1 offset:512
    v_mfma_f32_16x16x32_bf16 v[20:23], v[72:75], v[248:251], v[20:23]
    ds_read_b64_tr_b16 v[56:57], v1 offset:1024
    v_mfma_f32_16x16x32_bf16 v[20:23], v[48:51], v[36:39], v[20:23]
    ds_read_b64_tr_b16 v[58:59], v1 offset:1536
    v_mfma_f32_16x16x32_bf16 v[24:27], v[72:75], v[36:39], v[24:27]
    v_mfma_f32_16x16x32_bf16 v[24:27], v[48:51], v[44:47], v[24:27]
    v_mfma_f32_16x16x32_bf16 v[28:31], v[72:75], v[44:47], v[28:31]
    s_waitcnt lgkmcnt(2)
    v_mfma_f32_16x16x32_bf16 v[28:31], v[48:51], v[80:83], v[28:31]
    v_mfma_f32_16x16x32_bf16 v[32:35], v[72:75], v[80:83], v[32:35]
    v_mfma_f32_16x16x32_bf16 v[32:35], v[48:51], v[52:55], v[32:35]
    ds_read_b128 v[60:63], v2 offset:4288
    v_mfma_f32_16x16x32_bf16 v[12:15], v[88:91], v[248:251], v[12:15]
    s_waitcnt lgkmcnt(1)
    ds_read_b128 v[96:99], v2 offset:4416
    v_mfma_f32_16x16x32_bf16 v[12:15], v[56:59], v[36:39], v[12:15]
    s_barrier
    v_mfma_f32_16x16x32_bf16 v[16:19], v[88:91], v[36:39], v[16:19]
    ds_read_b64_tr_b16 v[100:101], v1 offset:2048
    v_mfma_f32_16x16x32_bf16 v[16:19], v[56:59], v[44:47], v[16:19]
    ds_read_b64_tr_b16 v[102:103], v1 offset:2560
    v_mfma_f32_16x16x32_bf16 v[20:23], v[88:91], v[44:47], v[20:23]
    ds_read_b64_tr_b16 v[64:65], v1 offset:3072
    v_mfma_f32_16x16x32_bf16 v[20:23], v[56:59], v[80:83], v[20:23]
    ds_read_b64_tr_b16 v[66:67], v1 offset:3584
    v_mfma_f32_16x16x32_bf16 v[24:27], v[88:91], v[80:83], v[24:27]
    v_mfma_f32_16x16x32_bf16 v[24:27], v[56:59], v[52:55], v[24:27]
    v_mfma_f32_16x16x32_bf16 v[28:31], v[88:91], v[52:55], v[28:31]
    s_waitcnt lgkmcnt(2)
    v_mfma_f32_16x16x32_bf16 v[28:31], v[56:59], v[60:63], v[28:31]
    v_mfma_f32_16x16x32_bf16 v[32:35], v[88:91], v[60:63], v[32:35]
    v_mfma_f32_16x16x32_bf16 v[32:35], v[56:59], v[96:99], v[32:35]
    ds_read_b128 v[68:71], v2 offset:4544
    v_mfma_f32_16x16x32_bf16 v[12:15], v[100:103], v[44:47], v[12:15]
    s_waitcnt lgkmcnt(1)
    ds_read_b128 v[112:115], v2 offset:4672
    v_mfma_f32_16x16x32_bf16 v[12:15], v[64:67], v[80:83], v[12:15]
    s_barrier
    v_mfma_f32_16x16x32_bf16 v[16:19], v[100:103], v[80:83], v[16:19]
    ds_read_b64_tr_b16 v[116:117], v1 offset:4096
    v_mfma_f32_16x16x32_bf16 v[16:19], v[64:67], v[52:55], v[16:19]
    ds_read_b64_tr_b16 v[118:119], v1 offset:4608
    v_mfma_f32_16x16x32_bf16 v[20:23], v[100:103], v[52:55], v[20:23]
    ds_read_b64_tr_b16 v[76:77], v1 offset:5120
    v_mfma_f32_16x16x32_bf16 v[20:23], v[64:67], v[60:63], v[20:23]
    ds_read_b64_tr_b16 v[78:79], v1 offset:5632
    v_mfma_f32_16x16x32_bf16 v[24:27], v[100:103], v[60:63], v[24:27]
    v_mfma_f32_16x16x32_bf16 v[24:27], v[64:67], v[96:99], v[24:27]
    v_mfma_f32_16x16x32_bf16 v[28:31], v[100:103], v[96:99], v[28:31]
    s_waitcnt lgkmcnt(2)
    ds_read_b128 v[84:87], v2 offset:4800
    v_mfma_f32_16x16x32_bf16 v[28:31], v[64:67], v[68:71], v[28:31]
    v_mfma_f32_16x16x32_bf16 v[32:35], v[100:103], v[68:71], v[32:35]
    ds_read_b128 v[128:131], v2 offset:4928
    v_mfma_f32_16x16x32_bf16 v[32:35], v[64:67], v[112:115], v[32:35]
    ds_read_b128 v[132:135], v2 offset:21376
    v_mfma_f32_16x16x32_bf16 v[12:15], v[116:119], v[52:55], v[12:15]
    s_waitcnt lgkmcnt(3)
    ds_read_b128 v[92:95], v2 offset:21504
    v_mfma_f32_16x16x32_bf16 v[12:15], v[76:79], v[60:63], v[12:15]
    s_barrier
    v_mfma_f32_16x16x32_bf16 v[16:19], v[116:119], v[60:63], v[16:19]
    ds_read_b64_tr_b16 v[104:105], v1 offset:6144
    v_mfma_f32_16x16x32_bf16 v[16:19], v[76:79], v[96:99], v[16:19]
    ds_read_b64_tr_b16 v[106:107], v1 offset:6656
    v_mfma_f32_16x16x32_bf16 v[20:23], v[116:119], v[96:99], v[20:23]
    ds_read_b64_tr_b16 v[144:145], v1 offset:7168
    v_mfma_f32_16x16x32_bf16 v[20:23], v[76:79], v[68:71], v[20:23]
    ds_read_b64_tr_b16 v[146:147], v1 offset:7680
    v_mfma_f32_16x16x32_bf16 v[24:27], v[116:119], v[68:71], v[24:27]
    v_mfma_f32_16x16x32_bf16 v[24:27], v[76:79], v[112:115], v[24:27]
    ds_read_b128 v[148:151], v2 offset:21632
    v_mfma_f32_16x16x32_bf16 v[28:31], v[116:119], v[112:115], v[28:31]
    s_waitcnt lgkmcnt(3)
    ds_read_b128 v[108:111], v2 offset:21760
    v_mfma_f32_16x16x32_bf16 v[28:31], v[76:79], v[84:87], v[28:31]
    v_mfma_f32_16x16x32_bf16 v[32:35], v[116:119], v[84:87], v[32:35]
    ds_read_b128 v[120:123], v2 offset:21888
    v_mfma_f32_16x16x32_bf16 v[32:35], v[76:79], v[128:131], v[32:35]
    ds_read_b128 v[160:163], v2 offset:22016
    v_mfma_f32_16x16x32_bf16 v[12:15], v[104:107], v[132:135], v[12:15]
    s_waitcnt lgkmcnt(3)
    ds_read_b128 v[164:167], v2 offset:23232
    v_mfma_f32_16x16x32_bf16 v[12:15], v[144:147], v[92:95], v[12:15]
    s_barrier
    v_mfma_f32_16x16x32_bf16 v[16:19], v[104:107], v[92:95], v[16:19]
    ds_read_b64_tr_b16 v[124:125], v1 offset:8192
    v_mfma_f32_16x16x32_bf16 v[16:19], v[144:147], v[148:151], v[16:19]
    ds_read_b64_tr_b16 v[126:127], v1 offset:8704
    v_mfma_f32_16x16x32_bf16 v[20:23], v[104:107], v[148:151], v[20:23]
    s_waitcnt lgkmcnt(3)
    ds_read_b64_tr_b16 v[176:177], v1 offset:9216
    v_mfma_f32_16x16x32_bf16 v[20:23], v[144:147], v[108:111], v[20:23]
    ds_read_b64_tr_b16 v[178:179], v1 offset:9728
L_pad0_2:
    s_cbranch_execz L_pad0_5
    v_mfma_f32_16x16x32_bf16 v[24:27], v[104:107], v[108:111], v[24:27]
    v_mfma_f32_16x16x32_bf16 v[24:27], v[144:147], v[120:123], v[24:27]
    v_mfma_f32_16x16x32_bf16 v[28:31], v[104:107], v[120:123], v[28:31]
    v_mfma_f32_16x16x32_bf16 v[28:31], v[144:147], v[160:163], v[28:31]
    v_mfma_f32_16x16x32_bf16 v[32:35], v[104:107], v[160:163], v[32:35]
    s_waitcnt lgkmcnt(0)
    v_mfma_f32_16x16x32_bf16 v[32:35], v[144:147], v[164:167], v[32:35]
    ds_read_b128 v[136:139], v2 offset:23360
    v_mfma_f32_16x16x32_bf16 v[12:15], v[124:127], v[148:151], v[12:15]
    ds_read_b128 v[188:191], v2 offset:23488
    v_mfma_f32_16x16x32_bf16 v[12:15], v[176:179], v[108:111], v[12:15]
    s_barrier
    v_mfma_f32_16x16x32_bf16 v[16:19], v[124:127], v[108:111], v[16:19]
    ds_read_b64_tr_b16 v[140:141], v1 offset:10240
    v_mfma_f32_16x16x32_bf16 v[16:19], v[176:179], v[120:123], v[16:19]
    ds_read_b64_tr_b16 v[142:143], v1 offset:10752
    v_mfma_f32_16x16x32_bf16 v[20:23], v[124:127], v[120:123], v[20:23]
    ds_read_b64_tr_b16 v[192:193], v1 offset:11264
    v_mfma_f32_16x16x32_bf16 v[20:23], v[176:179], v[160:163], v[20:23]
    ds_read_b64_tr_b16 v[194:195], v1 offset:11776
    v_mfma_f32_16x16x32_bf16 v[24:27], v[124:127], v[160:163], v[24:27]
    v_mfma_f32_16x16x32_bf16 v[24:27], v[176:179], v[164:167], v[24:27]
    v_mfma_f32_16x16x32_bf16 v[28:31], v[124:127], v[164:167], v[28:31]
    s_waitcnt lgkmcnt(2)
    v_mfma_f32_16x16x32_bf16 v[28:31], v[176:179], v[136:139], v[28:31]
    v_mfma_f32_16x16x32_bf16 v[32:35], v[124:127], v[136:139], v[32:35]
    v_mfma_f32_16x16x32_bf16 v[32:35], v[176:179], v[188:191], v[32:35]
    ds_read_b128 v[152:155], v2 offset:23616
    v_mfma_f32_16x16x32_bf16 v[12:15], v[140:143], v[120:123], v[12:15]
    s_waitcnt lgkmcnt(1)
    ds_read_b128 v[156:159], v2 offset:23744
    v_mfma_f32_16x16x32_bf16 v[12:15], v[192:195], v[160:163], v[12:15]
    s_barrier
    v_mfma_f32_16x16x32_bf16 v[16:19], v[140:143], v[160:163], v[16:19]
    ds_read_b64_tr_b16 v[168:169], v1 offset:12288
    v_mfma_f32_16x16x32_bf16 v[16:19], v[192:195], v[164:167], v[16:19]
    ds_read_b64_tr_b16 v[170:171], v1 offset:12800
    v_mfma_f32_16x16x32_bf16 v[20:23], v[140:143], v[164:167], v[20:23]
    ds_read_b64_tr_b16 v[172:173], v1 offset:13312
    v_mfma_f32_16x16x32_bf16 v[20:23], v[192:195], v[136:139], v[20:23]
    ds_read_b64_tr_b16 v[174:175], v1 offset:13824
    v_mfma_f32_16x16x32_bf16 v[24:27], v[140:143], v[136:139], v[24:27]
    v_mfma_f32_16x16x32_bf16 v[24:27], v[192:195], v[188:191], v[24:27]
    v_mfma_f32_16x16x32_bf16 v[28:31], v[140:143], v[188:191], v[28:31]
    s_waitcnt lgkmcnt(2)
    v_mfma_f32_16x16x32_bf16 v[28:31], v[192:195], v[152:155], v[28:31]
    v_mfma_f32_16x16x32_bf16 v[32:35], v[140:143], v[152:155], v[32:35]
    v_mfma_f32_16x16x32_bf16 v[32:35], v[192:195], v[156:159], v[32:35]
    ds_read_b128 v[180:183], v2 offset:23872
    v_mfma_f32_16x16x32_bf16 v[12:15], v[168:171], v[164:167], v[12:15]
    s_waitcnt lgkmcnt(1)
    ds_read_b128 v[212:215], v2 offset:24000
    v_mfma_f32_16x16x32_bf16 v[12:15], v[172:175], v[136:139], v[12:15]
    s_barrier
    v_mfma_f32_16x16x32_bf16 v[16:19], v[168:171], v[136:139], v[16:19]
    ds_read_b64_tr_b16 v[184:185], v1 offset:14336
    v_mfma_f32_16x16x32_bf16 v[16:19], v[172:175], v[188:191], v[16:19]
    ds_read_b64_tr_b16 v[186:187], v1 offset:14848
    v_mfma_f32_16x16x32_bf16 v[20:23], v[168:171], v[188:191], v[20:23]
    ds_read_b64_tr_b16 v[196:197], v1 offset:15360
    v_mfma_f32_16x16x32_bf16 v[20:23], v[172:175], v[152:155], v[20:23]
    ds_read_b64_tr_b16 v[198:199], v1 offset:15872
    v_mfma_f32_16x16x32_bf16 v[24:27], v[168:171], v[152:155], v[24:27]
    v_mfma_f32_16x16x32_bf16 v[24:27], v[172:175], v[156:159], v[24:27]
    v_mfma_f32_16x16x32_bf16 v[28:31], v[168:171], v[156:159], v[28:31]
    s_waitcnt lgkmcnt(2)
    v_mfma_f32_16x16x32_bf16 v[28:31], v[172:175], v[180:183], v[28:31]
    v_mfma_f32_16x16x32_bf16 v[32:35], v[168:171], v[180:183], v[32:35]
    v_mfma_f32_16x16x32_bf16 v[32:35], v[172:175], v[212:215], v[32:35]
    ds_read_b128 v[200:203], v2 offset:24128
    v_mfma_f32_16x16x32_bf16 v[12:15], v[184:187], v[188:191], v[12:15]
    s_waitcnt lgkmcnt(1)
    ds_read_b128 v[204:207], v2 offset:25344
    v_mfma_f32_16x16x32_bf16 v[12:15], v[196:199], v[152:155], v[12:15]
    s_barrier
    v_mfma_f32_16x16x32_bf16 v[16:19], v[184:187], v[152:155], v[16:19]
    ds_read_b64_tr_b16 v[208:209], v1 offset:16384
    v_mfma_f32_16x16x32_bf16 v[16:19], v[196:199], v[156:159], v[16:19]
    ds_read_b64_tr_b16 v[210:211], v1 offset:16896
    v_mfma_f32_16x16x32_bf16 v[20:23], v[184:187], v[156:159], v[20:23]
    ds_read_b64_tr_b16 v[216:217], v1 offset:17408
    v_mfma_f32_16x16x32_bf16 v[20:23], v[196:199], v[180:183], v[20:23]
    ds_read_b64_tr_b16 v[218:219], v1 offset:17920
    v_mfma_f32_16x16x32_bf16 v[24:27], v[184:187], v[180:183], v[24:27]
    v_mfma_f32_16x16x32_bf16 v[24:27], v[196:199], v[212:215], v[24:27]
    v_mfma_f32_16x16x32_bf16 v[28:31], v[184:187], v[212:215], v[28:31]
    s_waitcnt lgkmcnt(2)
    ds_read_b128 v[228:231], v2 offset:25472
    v_mfma_f32_16x16x32_bf16 v[28:31], v[196:199], v[200:203], v[28:31]
    v_mfma_f32_16x16x32_bf16 v[32:35], v[184:187], v[200:203], v[32:35]
    ds_read_b128 v[232:235], v2 offset:25600
    v_mfma_f32_16x16x32_bf16 v[32:35], v[196:199], v[204:207], v[32:35]
    ds_read_b128 v[244:247], v2 offset:25728
    v_mfma_f32_16x16x32_bf16 v[12:15], v[208:211], v[156:159], v[12:15]
    s_waitcnt lgkmcnt(3)
    ds_read_b128 v[248:251], v2 offset:25856
    v_mfma_f32_16x16x32_bf16 v[12:15], v[216:219], v[180:183], v[12:15]
    s_barrier
    v_mfma_f32_16x16x32_bf16 v[16:19], v[208:211], v[180:183], v[16:19]
    ds_read_b64_tr_b16 v[36:37], v1 offset:18432
    v_mfma_f32_16x16x32_bf16 v[16:19], v[216:219], v[212:215], v[16:19]
    ds_read_b64_tr_b16 v[38:39], v1 offset:18944
    v_mfma_f32_16x16x32_bf16 v[20:23], v[208:211], v[212:215], v[20:23]
    ds_read_b64_tr_b16 v[44:45], v1 offset:19456
    v_mfma_f32_16x16x32_bf16 v[20:23], v[216:219], v[200:203], v[20:23]
    ds_read_b64_tr_b16 v[46:47], v1 offset:19968
    v_mfma_f32_16x16x32_bf16 v[24:27], v[208:211], v[200:203], v[24:27]
    v_mfma_f32_16x16x32_bf16 v[24:27], v[216:219], v[204:207], v[24:27]
    ds_read_b128 v[80:83], v2 offset:21440
    v_mfma_f32_16x16x32_bf16 v[28:31], v[208:211], v[204:207], v[28:31]
    s_waitcnt lgkmcnt(3)
    ds_read_b128 v[52:55], v2 offset:21568
    v_mfma_f32_16x16x32_bf16 v[28:31], v[216:219], v[228:231], v[28:31]
    v_mfma_f32_16x16x32_bf16 v[32:35], v[208:211], v[228:231], v[32:35]
    ds_read_b128 v[60:63], v2 offset:21952
    v_mfma_f32_16x16x32_bf16 v[32:35], v[216:219], v[232:235], v[32:35]
    ds_read_b128 v[96:99], v2 offset:25984
    v_mfma_f32_16x16x32_bf16 v[12:15], v[36:39], v[212:215], v[12:15]
    s_waitcnt lgkmcnt(3)
    ds_read_b128 v[68:71], v2 offset:22080
    v_mfma_f32_16x16x32_bf16 v[12:15], v[44:47], v[200:203], v[12:15]
    s_barrier
    v_mfma_f32_16x16x32_bf16 v[16:19], v[36:39], v[200:203], v[16:19]
    ds_read_b64_tr_b16 v[112:113], v1 offset:20480
    v_mfma_f32_16x16x32_bf16 v[16:19], v[44:47], v[204:207], v[16:19]
    ds_read_b64_tr_b16 v[114:115], v1 offset:20992
    v_mfma_f32_16x16x32_bf16 v[20:23], v[36:39], v[204:207], v[20:23]
    ds_read_b64_tr_b16 v[84:85], v1 offset:21504
    v_mfma_f32_16x16x32_bf16 v[20:23], v[44:47], v[228:231], v[20:23]
    ds_read_b64_tr_b16 v[86:87], v1 offset:22016
    v_mfma_f32_16x16x32_bf16 v[24:27], v[36:39], v[228:231], v[24:27]
L_pad0_3:
    s_cbranch_execz L_main0
    v_mfma_f32_16x16x32_bf16 v[24:27], v[44:47], v[232:235], v[24:27]
    ds_read_b128 v[128:131], v2 offset:21696
    v_mfma_f32_16x16x32_bf16 v[28:31], v[36:39], v[232:235], v[28:31]
    ds_read_b128 v[132:135], v2 offset:21824
    v_mfma_f32_16x16x32_bf16 v[28:31], v[44:47], v[244:247], v[28:31]
    s_barrier
    v_mfma_f32_16x16x32_bf16 v[32:35], v[36:39], v[244:247], v[32:35]
    ds_read_b64_tr_b16 v[92:93], v1 offset:22528
    v_mfma_f32_16x16x32_bf16 v[32:35], v[44:47], v[248:251], v[32:35]
    s_waitcnt lgkmcnt(3)
    ds_read_b64_tr_b16 v[94:95], v1 offset:23040
    v_mfma_f32_16x16x32_bf16 v[12:15], v[112:115], v[204:207], v[12:15]
    ds_read_b64_tr_b16 v[148:149], v1 offset:23552
    v_mfma_f32_16x16x32_bf16 v[12:15], v[84:87], v[80:83], v[12:15]
    ds_read_b64_tr_b16 v[150:151], v1 offset:24064
    v_mfma_f32_16x16x32_bf16 v[16:19], v[112:115], v[228:231], v[16:19]
    v_mfma_f32_16x16x32_bf16 v[16:19], v[84:87], v[52:55], v[16:19]
    ds_read_b128 v[108:111], v2 offset:23296
    v_mfma_f32_16x16x32_bf16 v[28:31], v[112:115], v[248:251], v[28:31]
    ds_read_b128 v[120:123], v2 offset:23424
    v_mfma_f32_16x16x32_bf16 v[28:31], v[84:87], v[60:63], v[28:31]
    s_barrier
    v_mfma_f32_16x16x32_bf16 v[32:35], v[112:115], v[96:99], v[32:35]
    ds_read_b64_tr_b16 v[160:161], v1 offset:0
    v_mfma_f32_16x16x32_bf16 v[32:35], v[84:87], v[68:71], v[32:35]
    s_waitcnt lgkmcnt(3)
    ds_read_b64_tr_b16 v[162:163], v1 offset:512
    v_mfma_f32_16x16x32_bf16 v[12:15], v[92:95], v[52:55], v[12:15]
    ds_read_b64_tr_b16 v[164:165], v1 offset:1024
    v_mfma_f32_16x16x32_bf16 v[12:15], v[148:151], v[128:131], v[12:15]
    ds_read_b64_tr_b16 v[166:167], v1 offset:1536
    v_mfma_f32_16x16x32_bf16 v[16:19], v[92:95], v[128:131], v[16:19]
    v_mfma_f32_16x16x32_bf16 v[16:19], v[148:151], v[132:135], v[16:19]
    ds_read_b128 v[136:139], v2 offset:23552
    v_mfma_f32_16x16x32_bf16 v[28:31], v[92:95], v[68:71], v[28:31]
    s_waitcnt lgkmcnt(3)
    ds_read_b128 v[188:191], v2 offset:23680
    v_mfma_f32_16x16x32_bf16 v[28:31], v[148:151], v[108:111], v[28:31]
    s_barrier
    v_mfma_f32_16x16x32_bf16 v[32:35], v[92:95], v[108:111], v[32:35]
    ds_read_b64_tr_b16 v[152:153], v1 offset:2048
    v_mfma_f32_16x16x32_bf16 v[32:35], v[148:151], v[120:123], v[32:35]
    ds_read_b64_tr_b16 v[154:155], v1 offset:2560
    v_mfma_f32_16x16x32_bf16 v[12:15], v[160:163], v[132:135], v[12:15]
    s_waitcnt lgkmcnt(3)
    ds_read_b64_tr_b16 v[156:157], v1 offset:3072
    v_mfma_f32_16x16x32_bf16 v[12:15], v[164:167], v[60:63], v[12:15]
    ds_read_b64_tr_b16 v[158:159], v1 offset:3584
    v_mfma_f32_16x16x32_bf16 v[16:19], v[160:163], v[60:63], v[16:19]
    v_mfma_f32_16x16x32_bf16 v[16:19], v[164:167], v[68:71], v[16:19]
    ds_read_b128 v[180:183], v2 offset:23808
    v_mfma_f32_16x16x32_bf16 v[28:31], v[160:163], v[120:123], v[28:31]
    ds_read_b128 v[212:215], v2 offset:23936
    v_mfma_f32_16x16x32_bf16 v[28:31], v[164:167], v[136:139], v[28:31]
    s_barrier
    v_mfma_f32_16x16x32_bf16 v[32:35], v[160:163], v[136:139], v[32:35]
    s_waitcnt lgkmcnt(2)
    ds_read_b64_tr_b16 v[200:201], v1 offset:4096
    v_mfma_f32_16x16x32_bf16 v[32:35], v[164:167], v[188:191], v[32:35]
    ds_read_b64_tr_b16 v[202:203], v1 offset:4608
    v_mfma_f32_16x16x32_bf16 v[12:15], v[152:155], v[68:71], v[12:15]
    ds_read_b64_tr_b16 v[232:233], v1 offset:5120
    v_mfma_f32_16x16x32_bf16 v[12:15], v[156:159], v[108:111], v[12:15]
    ds_read_b64_tr_b16 v[234:235], v1 offset:5632
    v_mfma_f32_16x16x32_bf16 v[16:19], v[152:155], v[108:111], v[16:19]
    v_mfma_f32_16x16x32_bf16 v[16:19], v[156:159], v[120:123], v[16:19]
    ds_read_b128 v[244:247], v2 offset:24064
    v_mfma_f32_16x16x32_bf16 v[28:31], v[152:155], v[188:191], v[28:31]
    s_waitcnt lgkmcnt(3)
    ds_read_b128 v[204:207], v2 offset:24192
    v_mfma_f32_16x16x32_bf16 v[28:31], v[156:159], v[180:183], v[28:31]
    s_barrier
    v_mfma_f32_16x16x32_bf16 v[32:35], v[152:155], v[180:183], v[32:35]
    ds_read_b64_tr_b16 v[80:81], v1 offset:6144
    v_mfma_f32_16x16x32_bf16 v[32:35], v[156:159], v[212:215], v[32:35]
    ds_read_b64_tr_b16 v[82:83], v1 offset:6656
    v_mfma_f32_16x16x32_bf16 v[12:15], v[200:203], v[120:123], v[12:15]
    s_waitcnt lgkmcnt(3)
    ds_read_b64_tr_b16 v[228:229], v1 offset:7168
    v_mfma_f32_16x16x32_bf16 v[12:15], v[232:235], v[136:139], v[12:15]
    ds_read_b64_tr_b16 v[230:231], v1 offset:7680
    v_mfma_f32_16x16x32_bf16 v[16:19], v[200:203], v[136:139], v[16:19]
    v_mfma_f32_16x16x32_bf16 v[16:19], v[232:235], v[188:191], v[16:19]
    ds_read_b128 v[248:251], v2 offset:25408
    v_mfma_f32_16x16x32_bf16 v[28:31], v[200:203], v[212:215], v[28:31]
    ds_read_b128 v[96:99], v2 offset:25536
    v_mfma_f32_16x16x32_bf16 v[28:31], v[232:235], v[244:247], v[28:31]
    s_barrier
    v_mfma_f32_16x16x32_bf16 v[32:35], v[200:203], v[244:247], v[32:35]
    s_waitcnt lgkmcnt(2)
    ds_read_b64_tr_b16 v[52:53], v1 offset:8192
    v_mfma_f32_16x16x32_bf16 v[32:35], v[232:235], v[204:207], v[32:35]
    ds_read_b64_tr_b16 v[54:55], v1 offset:8704
    v_mfma_f32_16x16x32_bf16 v[12:15], v[80:83], v[188:191], v[12:15]
    ds_read_b64_tr_b16 v[128:129], v1 offset:9216
    v_mfma_f32_16x16x32_bf16 v[12:15], v[228:231], v[180:183], v[12:15]
    ds_read_b64_tr_b16 v[130:131], v1 offset:9728
    v_mfma_f32_16x16x32_bf16 v[16:19], v[80:83], v[180:183], v[16:19]
    v_mfma_f32_16x16x32_bf16 v[16:19], v[228:231], v[212:215], v[16:19]
    ds_read_b128 v[132:135], v2 offset:25664
    v_mfma_f32_16x16x32_bf16 v[28:31], v[80:83], v[204:207], v[28:31]
    s_waitcnt lgkmcnt(3)
    ds_read_b128 v[60:63], v2 offset:25792
    v_mfma_f32_16x16x32_bf16 v[28:31], v[228:231], v[248:251], v[28:31]
    s_barrier
    v_mfma_f32_16x16x32_bf16 v[32:35], v[80:83], v[248:251], v[32:35]
    ds_read_b64_tr_b16 v[68:69], v1 offset:10240
    v_mfma_f32_16x16x32_bf16 v[32:35], v[228:231], v[96:99], v[32:35]
    ds_read_b64_tr_b16 v[70:71], v1 offset:10752
    v_mfma_f32_16x16x32_bf16 v[12:15], v[52:55], v[212:215], v[12:15]
    s_waitcnt lgkmcnt(3)
    ds_read_b64_tr_b16 v[108:109], v1 offset:11264
    v_mfma_f32_16x16x32_bf16 v[12:15], v[128:131], v[244:247], v[12:15]
    ds_read_b64_tr_b16 v[110:111], v1 offset:11776
    v_mfma_f32_16x16x32_bf16 v[16:19], v[52:55], v[244:247], v[16:19]
    v_mfma_f32_16x16x32_bf16 v[16:19], v[128:131], v[204:207], v[16:19]
    v_mfma_f32_16x16x32_bf16 v[28:31], v[52:55], v[96:99], v[28:31]
    v_mfma_f32_16x16x32_bf16 v[28:31], v[128:131], v[132:135], v[28:31]
    ds_read_b128 v[120:123], v2 offset:25920
    v_mfma_f32_16x16x32_bf16 v[32:35], v[52:55], v[132:135], v[32:35]
    s_waitcnt lgkmcnt(1)
    ds_read_b128 v[136:139], v2 offset:26048
    v_mfma_f32_16x16x32_bf16 v[32:35], v[128:131], v[60:63], v[32:35]
    ds_read_b128 v[188:191], v2 offset:25600
    v_mfma_f32_16x16x32_bf16 v[12:15], v[68:71], v[204:207], v[12:15]
    v_mfma_f32_16x16x32_bf16 v[12:15], v[108:111], v[248:251], v[12:15]
    ds_read_b128 v[180:183], v2 offset:25728
    v_mfma_f32_16x16x32_bf16 v[16:19], v[68:71], v[248:251], v[16:19]
    ds_read_b128 v[212:215], v2 offset:21696
    v_mfma_f32_16x16x32_bf16 v[16:19], v[108:111], v[96:99], v[16:19]
    s_nop 0
    ds_read_b128 v[244:247], v2 offset:21824
    s_nop 0
    v_mfma_f32_16x16x32_bf16 v[28:31], v[68:71], v[60:63], v[28:31]
    s_waitcnt lgkmcnt(3)
    s_nop 1
    v_mfma_f32_16x16x32_bf16 v[28:31], v[108:111], v[120:123], v[28:31]
    ds_read_b128 v[132:135], v2 offset:21952
    v_cvt_pk_bf16_f32 v12, v12, v13
    v_mfma_f32_16x16x32_bf16 v[32:35], v[68:71], v[120:123], v[32:35]
    v_cvt_pk_bf16_f32 v13, v14, v15
    v_cvt_pk_bf16_f32 v14, v16, v17
    v_mfma_f32_16x16x32_bf16 v[32:35], v[108:111], v[136:139], v[32:35]
    ds_read_b128 v[204:207], v2 offset:22080
    v_cvt_pk_bf16_f32 v15, v18, v19
    v_mfma_f32_16x16x32_bf16 v[20:23], v[112:115], v[188:191], v[20:23]
    s_waitcnt lgkmcnt(2)
    v_min_u32 v12, -2, v12
    v_min_u32 v13, -2, v13
    v_mfma_f32_16x16x32_bf16 v[24:27], v[112:115], v[180:183], v[24:27]
    ds_read_b128 v[248:251], v2 offset:23296
    v_min_u32 v14, -2, v14
    v_mfma_f32_16x16x32_bf16 v[20:23], v[84:87], v[212:215], v[20:23]
    v_min_u32 v15, -2, v15
L_pad0_4:
    s_cbranch_execz L_main0
    v_mfma_f32_16x16x32_bf16 v[20:23], v[92:95], v[244:247], v[20:23]
    buffer_store_dwordx4 v[12:15], v3, s[28:31], s41 offen sc1
    ds_read_b128 v[96:99], v2 offset:23424
    v_cvt_pk_bf16_f32 v28, v28, v29
    v_cvt_pk_bf16_f32 v29, v30, v31
    v_cvt_pk_bf16_f32 v30, v32, v33
    v_mfma_f32_16x16x32_bf16 v[24:27], v[84:87], v[244:247], v[24:27]
    s_waitcnt lgkmcnt(2)
    v_cvt_pk_bf16_f32 v31, v34, v35
    v_min_u32 v28, -2, v28
    v_mfma_f32_16x16x32_bf16 v[24:27], v[92:95], v[132:135], v[24:27]
    ds_read_b128 v[60:63], v2 offset:23552
    v_min_u32 v29, -2, v29
    v_mfma_f32_16x16x32_bf16 v[20:23], v[148:151], v[132:135], v[20:23]
    v_min_u32 v30, -2, v30
    v_min_u32 v31, -2, v31
    v_mfma_f32_16x16x32_bf16 v[20:23], v[160:163], v[204:207], v[20:23]
    buffer_store_dwordx4 v[28:31], v3, s[28:31], s43 offen sc1
    ds_read_b128 v[120:123], v2 offset:23680
    v_mfma_f32_16x16x32_bf16 v[24:27], v[148:151], v[204:207], v[24:27]
    s_waitcnt lgkmcnt(2)
    v_mfma_f32_16x16x32_bf16 v[24:27], v[160:163], v[248:251], v[24:27]
    ds_read_b128 v[136:139], v2 offset:23808
    v_mfma_f32_16x16x32_bf16 v[20:23], v[164:167], v[248:251], v[20:23]
    v_mfma_f32_16x16x32_bf16 v[20:23], v[152:155], v[96:99], v[20:23]
    ds_read_b128 v[188:191], v2 offset:23936
    v_mfma_f32_16x16x32_bf16 v[24:27], v[164:167], v[96:99], v[24:27]
    s_waitcnt lgkmcnt(2)
    v_mfma_f32_16x16x32_bf16 v[24:27], v[152:155], v[60:63], v[24:27]
    ds_read_b128 v[180:183], v2 offset:24064
    v_mfma_f32_16x16x32_bf16 v[20:23], v[156:159], v[60:63], v[20:23]
    v_mfma_f32_16x16x32_bf16 v[20:23], v[200:203], v[120:123], v[20:23]
    ds_read_b128 v[212:215], v2 offset:24192
    v_mfma_f32_16x16x32_bf16 v[24:27], v[156:159], v[120:123], v[24:27]
    s_waitcnt lgkmcnt(2)
    v_mfma_f32_16x16x32_bf16 v[24:27], v[200:203], v[136:139], v[24:27]
    ds_read_b128 v[244:247], v2 offset:25408
    v_mfma_f32_16x16x32_bf16 v[20:23], v[232:235], v[136:139], v[20:23]
    v_mfma_f32_16x16x32_bf16 v[20:23], v[80:83], v[188:191], v[20:23]
    ds_read_b128 v[132:135], v2 offset:25536
    v_mfma_f32_16x16x32_bf16 v[24:27], v[232:235], v[188:191], v[24:27]
    s_waitcnt lgkmcnt(2)
    v_mfma_f32_16x16x32_bf16 v[24:27], v[80:83], v[180:183], v[24:27]
    ds_read_b128 v[204:207], v2 offset:25664
    v_mfma_f32_16x16x32_bf16 v[20:23], v[228:231], v[180:183], v[20:23]
    v_mfma_f32_16x16x32_bf16 v[20:23], v[52:55], v[212:215], v[20:23]
    ds_read_b128 v[248:251], v2 offset:25792
    v_mfma_f32_16x16x32_bf16 v[24:27], v[228:231], v[212:215], v[24:27]
    s_waitcnt lgkmcnt(2)
    ds_read_b128 v[96:99], v2 offset:192
    v_mfma_f32_16x16x32_bf16 v[24:27], v[52:55], v[244:247], v[24:27]
    ds_read_b128 v[60:63], v2 offset:320
    v_mfma_f32_16x16x32_bf16 v[20:23], v[128:131], v[244:247], v[20:23]
    v_mfma_f32_16x16x32_bf16 v[20:23], v[68:71], v[132:135], v[20:23]
    ds_read_b128 v[120:123], v2 offset:448
    v_mfma_f32_16x16x32_bf16 v[24:27], v[128:131], v[132:135], v[24:27]
    s_waitcnt lgkmcnt(3)
    v_mfma_f32_16x16x32_bf16 v[24:27], v[68:71], v[204:207], v[24:27]
    ds_read_b128 v[136:139], v2 offset:576
    v_mfma_f32_16x16x32_bf16 v[20:23], v[108:111], v[204:207], v[20:23]
    v_mfma_f32_16x16x32_bf16 v[24:27], v[108:111], v[248:251], v[24:27]
    s_waitcnt lgkmcnt(2)
    ds_read_b128 v[188:191], v2 offset:704
    s_nop 0
    v_mfma_f32_16x16x32_bf16 v[4:7], v[220:223], v[96:99], v[4:7]
    s_nop 0
    s_nop 1
    v_mfma_f32_16x16x32_bf16 v[4:7], v[224:227], v[60:63], v[4:7]
    ds_read_b128 v[180:183], v2 offset:832
    v_cvt_pk_bf16_f32 v20, v20, v21
    v_mfma_f32_16x16x32_bf16 v[8:11], v[220:223], v[60:63], v[8:11]
    s_waitcnt lgkmcnt(2)
    v_cvt_pk_bf16_f32 v21, v22, v23
    v_cvt_pk_bf16_f32 v22, v24, v25
    v_mfma_f32_16x16x32_bf16 v[8:11], v[224:227], v[120:123], v[8:11]
    ds_read_b128 v[212:215], v2 offset:960
    v_cvt_pk_bf16_f32 v23, v26, v27
    v_mfma_f32_16x16x32_bf16 v[4:7], v[236:239], v[120:123], v[4:7]
    v_min_u32 v20, -2, v20
    v_min_u32 v21, -2, v21
    v_mfma_f32_16x16x32_bf16 v[4:7], v[240:243], v[136:139], v[4:7]
    ds_read_b128 v[244:247], v2 offset:2176
    v_min_u32 v22, -2, v22
    v_mfma_f32_16x16x32_bf16 v[8:11], v[236:239], v[136:139], v[8:11]
    s_waitcnt lgkmcnt(2)
    v_min_u32 v23, -2, v23
    v_mfma_f32_16x16x32_bf16 v[8:11], v[240:243], v[188:191], v[8:11]
    buffer_store_dwordx4 v[20:23], v3, s[28:31], s42 offen sc1
    ds_read_b128 v[132:135], v2 offset:2304
    v_and_b32 v32, 15, v0
    v_lshrrev_b32 v24, 4, v0
    v_mad_u32_u24 v25, v32, 17, v24
    v_mfma_f32_16x16x32_bf16 v[4:7], v[252:255], v[188:191], v[4:7]
    s_lshl_b32 s12, s10, 6
    s_add_u32 s12, s12, 140544
    v_lshl_add_u32 v25, v25, 4, s12
    v_mfma_f32_16x16x32_bf16 v[4:7], v[40:43], v[180:183], v[4:7]
    ds_read_b128 v[204:207], v2 offset:2432
    v_mad_u32_u24 v26, v24, 17, v32
    v_mfma_f32_16x16x32_bf16 v[8:11], v[252:255], v[180:183], v[8:11]
    s_waitcnt lgkmcnt(2)
    s_mul_i32 s12, s10, 1088
    s_add_u32 s12, s12, 144896
    v_mfma_f32_16x16x32_bf16 v[8:11], v[40:43], v[212:215], v[8:11]
    ds_read_b128 v[248:251], v2 offset:2560
    v_lshl_add_u32 v26, v26, 4, s12
    v_mfma_f32_16x16x32_bf16 v[4:7], v[72:75], v[212:215], v[4:7]
    v_mul_u32_u24 v24, 9, v24
    v_and_b32 v24, 17, v24
    v_mfma_f32_16x16x32_bf16 v[4:7], v[48:51], v[244:247], v[4:7]
    s_lshl2_add_u32 s12, s7, s10
    ds_read_b128 v[96:99], v2 offset:2688
    s_lshl3_add_u32 s12, s12, s4
    v_mfma_f32_16x16x32_bf16 v[8:11], v[72:75], v[244:247], v[8:11]
    s_waitcnt lgkmcnt(2)
    s_lshl4_add_u32 s12, s12, s6
    s_add_u32 s12, s12, 8
    v_mfma_f32_16x16x32_bf16 v[8:11], v[48:51], v[132:135], v[8:11]
    s_lshl_b32 s12, s12, 7
    ds_read_b128 v[220:223], v2 offset:2816
    v_lshl_add_u32 v27, v24, 6, v32
    v_mfma_f32_16x16x32_bf16 v[4:7], v[88:91], v[132:135], v[4:7]
    v_lshl_add_u32 v27, v27, 3, s12
    v_mfma_f32_16x16x32_bf16 v[4:7], v[56:59], v[204:207], v[4:7]
    ds_read_b128 v[60:63], v2 offset:2944
    v_mfma_f32_16x16x32_bf16 v[8:11], v[88:91], v[204:207], v[8:11]
    s_waitcnt lgkmcnt(2)
    ds_read_b128 v[224:227], v2 offset:3072
    v_mfma_f32_16x16x32_bf16 v[8:11], v[56:59], v[248:251], v[8:11]
    v_mfma_f32_16x16x32_bf16 v[4:7], v[100:103], v[248:251], v[4:7]
    ds_read_b128 v[120:123], v2 offset:21120
    v_mfma_f32_16x16x32_bf16 v[4:7], v[64:67], v[96:99], v[4:7]
    ds_read_b128 v[236:239], v2 offset:21248
    v_mfma_f32_16x16x32_bf16 v[8:11], v[100:103], v[96:99], v[8:11]
    s_waitcnt lgkmcnt(3)
    ds_read_b128 v[136:139], v2 offset:21376
    v_mfma_f32_16x16x32_bf16 v[8:11], v[64:67], v[220:223], v[8:11]
    s_barrier
    v_mfma_f32_16x16x32_bf16 v[4:7], v[116:119], v[220:223], v[4:7]
    v_mfma_f32_16x16x32_bf16 v[4:7], v[76:79], v[60:63], v[4:7]
    ds_read_b128 v[240:243], v2 offset:21504
    v_mfma_f32_16x16x32_bf16 v[8:11], v[116:119], v[60:63], v[8:11]
    s_waitcnt lgkmcnt(2)
    v_mfma_f32_16x16x32_bf16 v[8:11], v[76:79], v[224:227], v[8:11]
    ds_read_b128 v[188:191], v2 offset:21632
    v_mfma_f32_16x16x32_bf16 v[4:7], v[104:107], v[120:123], v[4:7]
    v_mfma_f32_16x16x32_bf16 v[4:7], v[144:147], v[236:239], v[4:7]
    ds_read_b128 v[252:255], v2 offset:21760
    v_mfma_f32_16x16x32_bf16 v[8:11], v[104:107], v[236:239], v[8:11]
    s_waitcnt lgkmcnt(2)
    v_mfma_f32_16x16x32_bf16 v[8:11], v[144:147], v[136:139], v[8:11]
    ds_read_b128 v[180:183], v2 offset:21888
    v_mfma_f32_16x16x32_bf16 v[4:7], v[124:127], v[136:139], v[4:7]
L_pad0_5:
    s_cbranch_execz L_main0
    v_mfma_f32_16x16x32_bf16 v[4:7], v[176:179], v[240:243], v[4:7]
    ds_read_b128 v[40:43], v2 offset:22016
    v_mfma_f32_16x16x32_bf16 v[8:11], v[124:127], v[240:243], v[8:11]
    s_waitcnt lgkmcnt(2)
    v_mfma_f32_16x16x32_bf16 v[8:11], v[176:179], v[188:191], v[8:11]
    ds_read_b128 v[212:215], v2 offset:23232
    v_mfma_f32_16x16x32_bf16 v[4:7], v[140:143], v[188:191], v[4:7]
    v_mfma_f32_16x16x32_bf16 v[4:7], v[192:195], v[252:255], v[4:7]
    ds_read_b128 v[72:75], v2 offset:23360
    v_mfma_f32_16x16x32_bf16 v[8:11], v[140:143], v[252:255], v[8:11]
    s_waitcnt lgkmcnt(2)
    v_mfma_f32_16x16x32_bf16 v[8:11], v[192:195], v[180:183], v[8:11]
    ds_read_b128 v[244:247], v2 offset:23488
    v_mfma_f32_16x16x32_bf16 v[4:7], v[168:171], v[180:183], v[4:7]
    v_mfma_f32_16x16x32_bf16 v[4:7], v[172:175], v[40:43], v[4:7]
    ds_read_b128 v[48:51], v2 offset:23616
    v_mfma_f32_16x16x32_bf16 v[8:11], v[168:171], v[40:43], v[8:11]
    s_waitcnt lgkmcnt(2)
    v_mfma_f32_16x16x32_bf16 v[8:11], v[172:175], v[212:215], v[8:11]
    ds_read_b128 v[132:135], v2 offset:23744
    v_mfma_f32_16x16x32_bf16 v[4:7], v[184:187], v[212:215], v[4:7]
    v_mfma_f32_16x16x32_bf16 v[4:7], v[196:199], v[72:75], v[4:7]
    ds_read_b128 v[88:91], v2 offset:23872
    v_mfma_f32_16x16x32_bf16 v[8:11], v[184:187], v[72:75], v[8:11]
    s_waitcnt lgkmcnt(2)
    ds_read_b128 v[204:207], v2 offset:24000
    v_mfma_f32_16x16x32_bf16 v[8:11], v[196:199], v[244:247], v[8:11]
    v_mfma_f32_16x16x32_bf16 v[4:7], v[208:211], v[244:247], v[4:7]
    ds_read_b128 v[56:59], v2 offset:24128
    v_mfma_f32_16x16x32_bf16 v[4:7], v[216:219], v[48:51], v[4:7]
    ds_read_b128 v[248:251], v2 offset:21184
    v_mfma_f32_16x16x32_bf16 v[8:11], v[208:211], v[48:51], v[8:11]
    s_waitcnt lgkmcnt(3)
    ds_read_b128 v[100:103], v2 offset:21312
    v_mfma_f32_16x16x32_bf16 v[8:11], v[216:219], v[132:135], v[8:11]
    buffer_load_dwordx4 v[96:99], v3, s[28:31], s44 offen sc1
    v_mfma_f32_16x16x32_bf16 v[4:7], v[36:39], v[132:135], v[4:7]
    v_mfma_f32_16x16x32_bf16 v[4:7], v[44:47], v[88:91], v[4:7]
    ds_read_b128 v[64:67], v2 offset:21440
    v_mfma_f32_16x16x32_bf16 v[8:11], v[36:39], v[88:91], v[8:11]
    s_waitcnt lgkmcnt(2)
    v_mfma_f32_16x16x32_bf16 v[8:11], v[44:47], v[204:207], v[8:11]
    ds_read_b128 v[220:223], v2 offset:21568
    v_mfma_f32_16x16x32_bf16 v[4:7], v[112:115], v[204:207], v[4:7]
    v_mfma_f32_16x16x32_bf16 v[8:11], v[112:115], v[56:59], v[8:11]
    ds_read_b128 v[116:119], v2 offset:21696
    v_mfma_f32_16x16x32_bf16 v[4:7], v[84:87], v[248:251], v[4:7]
    s_waitcnt lgkmcnt(2)
    v_mfma_f32_16x16x32_bf16 v[4:7], v[92:95], v[100:103], v[4:7]
    ds_read_b128 v[60:63], v2 offset:21824
    v_mfma_f32_16x16x32_bf16 v[8:11], v[84:87], v[100:103], v[8:11]
    v_mfma_f32_16x16x32_bf16 v[8:11], v[92:95], v[64:67], v[8:11]
    ds_read_b128 v[76:79], v2 offset:21952
    v_mfma_f32_16x16x32_bf16 v[4:7], v[148:151], v[64:67], v[4:7]
    s_waitcnt lgkmcnt(2)
    v_mfma_f32_16x16x32_bf16 v[4:7], v[160:163], v[220:223], v[4:7]
    ds_read_b128 v[224:227], v2 offset:22080
    v_mfma_f32_16x16x32_bf16 v[8:11], v[148:151], v[220:223], v[8:11]
    v_mfma_f32_16x16x32_bf16 v[8:11], v[160:163], v[116:119], v[8:11]
    ds_read_b128 v[120:123], v2 offset:23296
    v_mfma_f32_16x16x32_bf16 v[4:7], v[164:167], v[116:119], v[4:7]
    s_waitcnt lgkmcnt(2)
    v_mfma_f32_16x16x32_bf16 v[4:7], v[152:155], v[60:63], v[4:7]
    ds_read_b128 v[104:107], v2 offset:23424
    v_mfma_f32_16x16x32_bf16 v[8:11], v[164:167], v[60:63], v[8:11]
    v_mfma_f32_16x16x32_bf16 v[8:11], v[152:155], v[76:79], v[8:11]
    ds_read_b128 v[236:239], v2 offset:23552
    v_mfma_f32_16x16x32_bf16 v[4:7], v[156:159], v[76:79], v[4:7]
    s_waitcnt lgkmcnt(2)
    v_mfma_f32_16x16x32_bf16 v[4:7], v[200:203], v[224:227], v[4:7]
    ds_read_b128 v[144:147], v2 offset:23680
    v_mfma_f32_16x16x32_bf16 v[8:11], v[156:159], v[224:227], v[8:11]
    v_mfma_f32_16x16x32_bf16 v[8:11], v[200:203], v[120:123], v[8:11]
    ds_read_b128 v[136:139], v2 offset:23808
    v_mfma_f32_16x16x32_bf16 v[4:7], v[232:235], v[120:123], v[4:7]
    s_waitcnt lgkmcnt(2)
    v_mfma_f32_16x16x32_bf16 v[4:7], v[80:83], v[104:107], v[4:7]
    ds_read_b128 v[124:127], v2 offset:23936
    v_mfma_f32_16x16x32_bf16 v[8:11], v[232:235], v[104:107], v[8:11]
    v_mfma_f32_16x16x32_bf16 v[8:11], v[80:83], v[236:239], v[8:11]
    ds_read_b128 v[240:243], v2 offset:24064
    v_mfma_f32_16x16x32_bf16 v[4:7], v[228:231], v[236:239], v[4:7]
    s_waitcnt lgkmcnt(2)
    v_mfma_f32_16x16x32_bf16 v[4:7], v[52:55], v[144:147], v[4:7]
    ds_read_b128 v[176:179], v2 offset:24192
    v_mfma_f32_16x16x32_bf16 v[8:11], v[228:231], v[144:147], v[8:11]
    v_mfma_f32_16x16x32_bf16 v[8:11], v[52:55], v[136:139], v[8:11]
    v_mfma_f32_16x16x32_bf16 v[4:7], v[128:131], v[136:139], v[4:7]
    s_waitcnt lgkmcnt(1)
    v_mfma_f32_16x16x32_bf16 v[4:7], v[68:71], v[124:127], v[4:7]
    v_mfma_f32_16x16x32_bf16 v[8:11], v[128:131], v[124:127], v[8:11]
    v_mfma_f32_16x16x32_bf16 v[8:11], v[68:71], v[240:243], v[8:11]
    v_mfma_f32_16x16x32_bf16 v[4:7], v[108:111], v[240:243], v[4:7]
    s_waitcnt lgkmcnt(0)
    s_waitcnt vmcnt(0)
    v_max3_u32 v188, v96, v97, v98
    v_mfma_f32_16x16x32_bf16 v[8:11], v[108:111], v[176:179], v[8:11]
    v_max_u32 v188, v188, v99
    v_cmp_eq_u32 vcc, -1, v188
    s_cbranch_vccnz L_again0
L_fin0:
    v_lshlrev_b32 v188, 16, v96
    v_and_b32 v189, s38, v96
    v_lshlrev_b32 v190, 16, v97
    v_and_b32 v191, s38, v97
    v_lshlrev_b32 v140, 16, v98
    v_and_b32 v141, s38, v98
    v_lshlrev_b32 v142, 16, v99
    v_and_b32 v143, s38, v99
    v_pk_add_f32 v[188:189], v[188:189], v[4:5]
    v_pk_add_f32 v[190:191], v[190:191], v[6:7]
    v_pk_mul_f32 v[188:189], v[188:189], s[36:37]
    v_pk_mul_f32 v[190:191], v[190:191], s[36:37]
    v_exp_f32 v188, v188
    v_exp_f32 v189, v189
    v_exp_f32 v190, v190
    v_exp_f32 v191, v191
    v_pk_add_f32 v[140:141], v[140:141], v[8:9]
    v_pk_add_f32 v[142:143], v[142:143], v[10:11]
    v_pk_mul_f32 v[140:141], v[140:141], s[36:37]
    v_pk_mul_f32 v[142:143], v[142:143], s[36:37]
    v_pk_add_f32 v[188:189], v[188:189], 1.0 op_sel_hi:[1,0]
    v_pk_add_f32 v[190:191], v[190:191], 1.0 op_sel_hi:[1,0]
    v_rcp_f32 v188, v188
    v_rcp_f32 v189, v189
    v_rcp_f32 v190, v190
    v_rcp_f32 v191, v191
    v_exp_f32 v140, v140
    v_exp_f32 v141, v141
    v_exp_f32 v142, v142
    v_exp_f32 v143, v143
    ds_write_b128 v25, v[188:191] offset:0
    v_pk_add_f32 v[140:141], v[140:141], 1.0 op_sel_hi:[1,0]
    v_pk_add_f32 v[142:143], v[142:143], 1.0 op_sel_hi:[1,0]
    v_rcp_f32 v140, v140
    v_rcp_f32 v141, v141
    v_rcp_f32 v142, v142
    v_rcp_f32 v143, v143
    s_nop 0
    ds_write_b128 v25, v[140:143] offset:4352
    s_waitcnt lgkmcnt(0)
    s_barrier
    ds_read_b128 v[252:255], v26
    ds_read_b128 v[192:195], v26 offset:8704
    s_waitcnt lgkmcnt(0)
    v_pk_mul_f32 v[252:253], v[252:253], v[192:193]
    v_pk_mul_f32 v[254:255], v[254:255], v[194:195]
    v_pk_fma_f32 v[252:253], v[252:253], -2.0, v[192:193] op_sel_hi:[1,0,1]
    v_pk_fma_f32 v[254:255], v[254:255], -2.0, v[194:195] op_sel_hi:[1,0,1]
    v_cvt_pk_bf16_f32 v252, v252, v253
    v_cvt_pk_bf16_f32 v253, v254, v255
    buffer_store_dwordx2 v[252:253], v27, s[24:27], 0 offen
    s_endpgm
L_again0:
    s_add_u32 s13, s13, 1
    s_cmp_ge_u32 s13, 200000
    s_cbranch_scc1 L_fin0
    buffer_load_dwordx4 v[96:99], v3, s[28:31], s44 offen sc1
    s_waitcnt vmcnt(0)
    v_max3_u32 v188, v96, v97, v98
    v_max_u32 v188, v188, v99
    v_cmp_eq_u32 vcc, -1, v188
    s_cbranch_vccnz L_again0
    s_branch L_fin0
.p2align 12
L_role1:
    s_load_dwordx2 s[28:29], s[0:1], 32
    s_load_dwordx2 s[24:25], s[0:1], 16
    s_cmp_eq_u32 s10, 1
    s_cbranch_scc1 L_pad1_0
    s_cmp_eq_u32 s10, 2
    s_cbranch_scc1 L_pad1_1
    s_cmp_eq_u32 s10, 3
    s_cbranch_scc1 L_pad1_2
L_main1:
    s_mov_b64 exec, -1
    s_setprio 1
    s_waitcnt vmcnt(0) lgkmcnt(0)
    s_barrier
    ds_read_b64_tr_b16 v[36:37], v1 offset:0
    ds_read_b64_tr_b16 v[38:39], v1 offset:512
    ds_read_b128 v[40:43], v2 offset:0
    ds_read_b128 v[44:47], v2 offset:128
    ds_read_b128 v[48:51], v2 offset:256
    ds_read_b128 v[52:55], v2 offset:384
    ds_read_b128 v[56:59], v2 offset:512
    ds_read_b128 v[60:63], v2 offset:640
    s_waitcnt lgkmcnt(5)
    v_mfma_f32_16x16x32_bf16 v[4:7], v[36:39], v[40:43], 0
    s_waitcnt lgkmcnt(4)
    ds_read_b128 v[64:67], v2 offset:768
    v_mfma_f32_16x16x32_bf16 v[8:11], v[36:39], v[44:47], 0
    s_waitcnt lgkmcnt(4)
    ds_read_b128 v[68:71], v2 offset:896
    v_mfma_f32_16x16x32_bf16 v[12:15], v[36:39], v[48:51], 0
    s_waitcnt lgkmcnt(4)
    v_mfma_f32_16x16x32_bf16 v[16:19], v[36:39], v[52:55], 0
    s_waitcnt lgkmcnt(3)
    s_barrier
    ds_read_b64_tr_b16 v[72:73], v1 offset:1024
    v_mfma_f32_16x16x32_bf16 v[20:23], v[36:39], v[56:59], 0
    s_waitcnt lgkmcnt(3)
    ds_read_b64_tr_b16 v[74:75], v1 offset:1536
    v_mfma_f32_16x16x32_bf16 v[24:27], v[36:39], v[60:63], 0
    s_waitcnt lgkmcnt(3)
    ds_read_b128 v[76:79], v2 offset:2112
    v_mfma_f32_16x16x32_bf16 v[28:31], v[36:39], v[64:67], 0
    s_waitcnt lgkmcnt(3)
    s_barrier
    v_mfma_f32_16x16x32_bf16 v[32:35], v[36:39], v[68:71], 0
    s_waitcnt lgkmcnt(1)
    ds_read_b64_tr_b16 v[80:81], v1 offset:2048
    v_mfma_f32_16x16x32_bf16 v[4:7], v[72:75], v[44:47], v[4:7]
    ds_read_b64_tr_b16 v[82:83], v1 offset:2560
    v_mfma_f32_16x16x32_bf16 v[8:11], v[72:75], v[48:51], v[8:11]
    v_mfma_f32_16x16x32_bf16 v[12:15], v[72:75], v[52:55], v[12:15]
    v_mfma_f32_16x16x32_bf16 v[16:19], v[72:75], v[56:59], v[16:19]
    v_mfma_f32_16x16x32_bf16 v[20:23], v[72:75], v[60:63], v[20:23]
    v_mfma_f32_16x16x32_bf16 v[24:27], v[72:75], v[64:67], v[24:27]
    s_lshr_b32 s9, s2, 2
    ds_read_b128 v[84:87], v2 offset:2240
    s_and_b32 s6, s9, 3
    v_mfma_f32_16x16x32_bf16 v[28:31], v[72:75], v[68:71], v[28:31]
    s_waitcnt lgkmcnt(1)
    s_barrier
    v_mfma_f32_16x16x32_bf16 v[32:35], v[72:75], v[76:79], v[32:35]
    s_lshr_b32 s7, s2, 5
    ds_read_b64_tr_b16 v[88:89], v1 offset:3072
    s_mov_b32 s26, 512000
    v_mfma_f32_16x16x32_bf16 v[4:7], v[80:83], v[48:51], v[4:7]
    s_mov_b32 s27, 0x20000
    ds_read_b64_tr_b16 v[90:91], v1 offset:3584
    s_bitcmp1_b32 s2, 4
    v_mfma_f32_16x16x32_bf16 v[8:11], v[80:83], v[52:55], v[8:11]
    s_cselect_b32 s8, s26, 0
    s_mov_b32 s30, 3162112
    s_mov_b32 s31, s27
    v_mfma_f32_16x16x32_bf16 v[12:15], v[80:83], v[56:59], v[12:15]
    s_lshl_b32 s12, s10, 10
    v_lshl_add_u32 v3, v0, 4, s12
    s_mul_i32 s12, s9, 49408
    v_mfma_f32_16x16x32_bf16 v[16:19], v[80:83], v[60:63], v[16:19]
    s_add_u32 s40, s12, 0
    s_add_u32 s42, s12, 32768
    s_add_u32 s43, s12, 40960
    v_mfma_f32_16x16x32_bf16 v[20:23], v[80:83], v[64:67], v[20:23]
    s_add_u32 s44, s12, 16384
    ds_read_b128 v[92:95], v2 offset:2368
    s_mov_b32 s13, 0
    v_mfma_f32_16x16x32_bf16 v[24:27], v[80:83], v[68:71], v[24:27]
    s_barrier
    s_mov_b32 s38, 0xffff0000
    v_mfma_f32_16x16x32_bf16 v[28:31], v[80:83], v[76:79], v[28:31]
    s_waitcnt lgkmcnt(1)
    ds_read_b64_tr_b16 v[96:97], v1 offset:4096
    s_mov_b32 s36, 0xbfb8aa3b
    v_mfma_f32_16x16x32_bf16 v[32:35], v[80:83], v[84:87], v[32:35]
    s_mov_b32 s37, s36
    ds_read_b64_tr_b16 v[98:99], v1 offset:4608
    s_add_u32 s24, s24, s8
    v_mfma_f32_16x16x32_bf16 v[4:7], v[88:91], v[52:55], v[4:7]
    s_addc_u32 s25, s25, 0
    ds_read_b64_tr_b16 v[100:101], v1 offset:5120
    v_mfma_f32_16x16x32_bf16 v[8:11], v[88:91], v[56:59], v[8:11]
    ds_read_b64_tr_b16 v[102:103], v1 offset:5632
    v_mfma_f32_16x16x32_bf16 v[12:15], v[88:91], v[60:63], v[12:15]
    v_mfma_f32_16x16x32_bf16 v[16:19], v[88:91], v[64:67], v[16:19]
    v_mfma_f32_16x16x32_bf16 v[20:23], v[88:91], v[68:71], v[20:23]
    v_mfma_f32_16x16x32_bf16 v[24:27], v[88:91], v[76:79], v[24:27]
    v_mfma_f32_16x16x32_bf16 v[28:31], v[88:91], v[84:87], v[28:31]
    s_waitcnt lgkmcnt(0)
    v_mfma_f32_16x16x32_bf16 v[32:35], v[88:91], v[92:95], v[32:35]
    v_mfma_f32_16x16x32_bf16 v[4:7], v[96:99], v[56:59], v[4:7]
    v_mfma_f32_16x16x32_bf16 v[4:7], v[100:103], v[60:63], v[4:7]
    v_mfma_f32_16x16x32_bf16 v[8:11], v[96:99], v[60:63], v[8:11]
    v_mfma_f32_16x16x32_bf16 v[8:11], v[100:103], v[64:67], v[8:11]
    ds_read_b128 v[104:107], v2 offset:2496
    v_mfma_f32_16x16x32_bf16 v[12:15], v[96:99], v[64:67], v[12:15]
    ds_read_b128 v[108:111], v2 offset:2624
    v_mfma_f32_16x16x32_bf16 v[12:15], v[100:103], v[68:71], v[12:15]
    s_barrier
    v_mfma_f32_16x16x32_bf16 v[16:19], v[96:99], v[68:71], v[16:19]
    ds_read_b64_tr_b16 v[112:113], v1 offset:6144
    v_mfma_f32_16x16x32_bf16 v[16:19], v[100:103], v[76:79], v[16:19]
    ds_read_b64_tr_b16 v[114:115], v1 offset:6656
    v_mfma_f32_16x16x32_bf16 v[20:23], v[96:99], v[76:79], v[20:23]
    ds_read_b64_tr_b16 v[116:117], v1 offset:7168
    v_mfma_f32_16x16x32_bf16 v[20:23], v[100:103], v[84:87], v[20:23]
    ds_read_b64_tr_b16 v[118:119], v1 offset:7680
    v_mfma_f32_16x16x32_bf16 v[24:27], v[96:99], v[84:87], v[24:27]
    v_mfma_f32_16x16x32_bf16 v[24:27], v[100:103], v[92:95], v[24:27]
    v_mfma_f32_16x16x32_bf16 v[28:31], v[96:99], v[92:95], v[28:31]
    s_waitcnt lgkmcnt(2)
    v_mfma_f32_16x16x32_bf16 v[28:31], v[100:103], v[104:107], v[28:31]
    v_mfma_f32_16x16x32_bf16 v[32:35], v[96:99], v[104:107], v[32:35]
    v_mfma_f32_16x16x32_bf16 v[32:35], v[100:103], v[108:111], v[32:35]
    v_mfma_f32_16x16x32_bf16 v[4:7], v[112:115], v[64:67], v[4:7]
    s_waitcnt lgkmcnt(0)
    v_mfma_f32_16x16x32_bf16 v[4:7], v[116:119], v[68:71], v[4:7]
    v_mfma_f32_16x16x32_bf16 v[8:11], v[112:115], v[68:71], v[8:11]
    v_mfma_f32_16x16x32_bf16 v[8:11], v[116:119], v[76:79], v[8:11]
    ds_read_b128 v[120:123], v2 offset:2752
    v_mfma_f32_16x16x32_bf16 v[12:15], v[112:115], v[76:79], v[12:15]
    ds_read_b128 v[124:127], v2 offset:2880
    v_mfma_f32_16x16x32_bf16 v[12:15], v[116:119], v[84:87], v[12:15]
    s_barrier
    v_mfma_f32_16x16x32_bf16 v[16:19], v[112:115], v[84:87], v[16:19]
    ds_read_b64_tr_b16 v[128:129], v1 offset:8192
    v_mfma_f32_16x16x32_bf16 v[16:19], v[116:119], v[92:95], v[16:19]
    ds_read_b64_tr_b16 v[130:131], v1 offset:8704
    v_mfma_f32_16x16x32_bf16 v[20:23], v[112:115], v[92:95], v[20:23]
    ds_read_b64_tr_b16 v[132:133], v1 offset:9216
    v_mfma_f32_16x16x32_bf16 v[20:23], v[116:119], v[104:107], v[20:23]
    ds_read_b64_tr_b16 v[134:135], v1 offset:9728
    v_mfma_f32_16x16x32_bf16 v[24:27], v[112:115], v[104:107], v[24:27]
    v_mfma_f32_16x16x32_bf16 v[24:27], v[116:119], v[108:111], v[24:27]
L_pad1_0:
    s_cbranch_execz L_pad1_3
    v_mfma_f32_16x16x32_bf16 v[28:31], v[112:115], v[108:111], v[28:31]
    s_waitcnt lgkmcnt(2)
    v_mfma_f32_16x16x32_bf16 v[28:31], v[116:119], v[120:123], v[28:31]
    v_mfma_f32_16x16x32_bf16 v[32:35], v[112:115], v[120:123], v[32:35]
    v_mfma_f32_16x16x32_bf16 v[32:35], v[116:119], v[124:127], v[32:35]
    v_mfma_f32_16x16x32_bf16 v[4:7], v[128:131], v[76:79], v[4:7]
    s_waitcnt lgkmcnt(0)
    v_mfma_f32_16x16x32_bf16 v[4:7], v[132:135], v[84:87], v[4:7]
    v_mfma_f32_16x16x32_bf16 v[8:11], v[128:131], v[84:87], v[8:11]
    v_mfma_f32_16x16x32_bf16 v[8:11], v[132:135], v[92:95], v[8:11]
    ds_read_b128 v[136:139], v2 offset:3008
    v_mfma_f32_16x16x32_bf16 v[12:15], v[128:131], v[92:95], v[12:15]
    ds_read_b128 v[140:143], v2 offset:4224
    v_mfma_f32_16x16x32_bf16 v[12:15], v[132:135], v[104:107], v[12:15]
    s_barrier
    v_mfma_f32_16x16x32_bf16 v[16:19], v[128:131], v[104:107], v[16:19]
    ds_read_b64_tr_b16 v[144:145], v1 offset:10240
    v_mfma_f32_16x16x32_bf16 v[16:19], v[132:135], v[108:111], v[16:19]
    ds_read_b64_tr_b16 v[146:147], v1 offset:10752
    v_mfma_f32_16x16x32_bf16 v[20:23], v[128:131], v[108:111], v[20:23]
    ds_read_b64_tr_b16 v[148:149], v1 offset:11264
    v_mfma_f32_16x16x32_bf16 v[20:23], v[132:135], v[120:123], v[20:23]
    ds_read_b64_tr_b16 v[150:151], v1 offset:11776
    v_mfma_f32_16x16x32_bf16 v[24:27], v[128:131], v[120:123], v[24:27]
    v_mfma_f32_16x16x32_bf16 v[24:27], v[132:135], v[124:127], v[24:27]
    v_mfma_f32_16x16x32_bf16 v[28:31], v[128:131], v[124:127], v[28:31]
    s_waitcnt lgkmcnt(2)
    v_mfma_f32_16x16x32_bf16 v[28:31], v[132:135], v[136:139], v[28:31]
    v_mfma_f32_16x16x32_bf16 v[32:35], v[128:131], v[136:139], v[32:35]
    v_mfma_f32_16x16x32_bf16 v[32:35], v[132:135], v[140:143], v[32:35]
    v_mfma_f32_16x16x32_bf16 v[4:7], v[144:147], v[92:95], v[4:7]
    s_waitcnt lgkmcnt(0)
    v_mfma_f32_16x16x32_bf16 v[4:7], v[148:151], v[104:107], v[4:7]
    v_mfma_f32_16x16x32_bf16 v[8:11], v[144:147], v[104:107], v[8:11]
    v_mfma_f32_16x16x32_bf16 v[8:11], v[148:151], v[108:111], v[8:11]
    ds_read_b128 v[152:155], v2 offset:4352
    v_mfma_f32_16x16x32_bf16 v[12:15], v[144:147], v[108:111], v[12:15]
    ds_read_b128 v[156:159], v2 offset:4480
    v_mfma_f32_16x16x32_bf16 v[12:15], v[148:151], v[120:123], v[12:15]
    s_barrier
    v_mfma_f32_16x16x32_bf16 v[16:19], v[144:147], v[120:123], v[16:19]
    ds_read_b64_tr_b16 v[160:161], v1 offset:12288
    v_mfma_f32_16x16x32_bf16 v[16:19], v[148:151], v[124:127], v[16:19]
    ds_read_b64_tr_b16 v[162:163], v1 offset:12800
    v_mfma_f32_16x16x32_bf16 v[20:23], v[144:147], v[124:127], v[20:23]
    ds_read_b64_tr_b16 v[164:165], v1 offset:13312
    v_mfma_f32_16x16x32_bf16 v[20:23], v[148:151], v[136:139], v[20:23]
    ds_read_b64_tr_b16 v[166:167], v1 offset:13824
    v_mfma_f32_16x16x32_bf16 v[24:27], v[144:147], v[136:139], v[24:27]
    v_mfma_f32_16x16x32_bf16 v[24:27], v[148:151], v[140:143], v[24:27]
    v_mfma_f32_16x16x32_bf16 v[28:31], v[144:147], v[140:143], v[28:31]
    s_waitcnt lgkmcnt(2)
    v_mfma_f32_16x16x32_bf16 v[28:31], v[148:151], v[152:155], v[28:31]
    v_mfma_f32_16x16x32_bf16 v[32:35], v[144:147], v[152:155], v[32:35]
    v_mfma_f32_16x16x32_bf16 v[32:35], v[148:151], v[156:159], v[32:35]
    v_mfma_f32_16x16x32_bf16 v[4:7], v[160:163], v[108:111], v[4:7]
    s_waitcnt lgkmcnt(0)
    v_mfma_f32_16x16x32_bf16 v[4:7], v[164:167], v[120:123], v[4:7]
    v_mfma_f32_16x16x32_bf16 v[8:11], v[160:163], v[120:123], v[8:11]
    ds_read_b128 v[168:171], v2 offset:4608
    v_mfma_f32_16x16x32_bf16 v[8:11], v[164:167], v[124:127], v[8:11]
    ds_read_b128 v[172:175], v2 offset:4736
    v_mfma_f32_16x16x32_bf16 v[12:15], v[160:163], v[124:127], v[12:15]
    ds_read_b128 v[176:179], v2 offset:64
    v_mfma_f32_16x16x32_bf16 v[12:15], v[164:167], v[136:139], v[12:15]
    s_barrier
    v_mfma_f32_16x16x32_bf16 v[16:19], v[160:163], v[136:139], v[16:19]
    ds_read_b64_tr_b16 v[180:181], v1 offset:14336
    v_mfma_f32_16x16x32_bf16 v[16:19], v[164:167], v[140:143], v[16:19]
    ds_read_b64_tr_b16 v[182:183], v1 offset:14848
    v_mfma_f32_16x16x32_bf16 v[20:23], v[160:163], v[140:143], v[20:23]
    ds_read_b64_tr_b16 v[184:185], v1 offset:15360
    v_mfma_f32_16x16x32_bf16 v[20:23], v[164:167], v[152:155], v[20:23]
    ds_read_b64_tr_b16 v[186:187], v1 offset:15872
    v_mfma_f32_16x16x32_bf16 v[24:27], v[160:163], v[152:155], v[24:27]
    v_mfma_f32_16x16x32_bf16 v[24:27], v[164:167], v[156:159], v[24:27]
    ds_read_b128 v[188:191], v2 offset:192
    v_mfma_f32_16x16x32_bf16 v[28:31], v[160:163], v[156:159], v[28:31]
    s_waitcnt lgkmcnt(3)
    ds_read_b128 v[192:195], v2 offset:320
    v_mfma_f32_16x16x32_bf16 v[28:31], v[164:167], v[168:171], v[28:31]
    v_mfma_f32_16x16x32_bf16 v[32:35], v[160:163], v[168:171], v[32:35]
    ds_read_b128 v[196:199], v2 offset:448
    v_mfma_f32_16x16x32_bf16 v[32:35], v[164:167], v[172:175], v[32:35]
    ds_read_b128 v[200:203], v2 offset:576
    v_mfma_f32_16x16x32_bf16 v[4:7], v[180:183], v[124:127], v[4:7]
    s_waitcnt lgkmcnt(3)
    ds_read_b128 v[204:207], v2 offset:704
    v_mfma_f32_16x16x32_bf16 v[4:7], v[184:187], v[176:179], v[4:7]
    v_mfma_f32_16x16x32_bf16 v[8:11], v[180:183], v[136:139], v[8:11]
    ds_read_b128 v[208:211], v2 offset:832
    v_mfma_f32_16x16x32_bf16 v[8:11], v[184:187], v[188:191], v[8:11]
    ds_read_b128 v[212:215], v2 offset:4864
    v_mfma_f32_16x16x32_bf16 v[12:15], v[180:183], v[140:143], v[12:15]
    s_waitcnt lgkmcnt(3)
    ds_read_b128 v[216:219], v2 offset:960
    v_mfma_f32_16x16x32_bf16 v[12:15], v[184:187], v[192:195], v[12:15]
    s_barrier
    v_mfma_f32_16x16x32_bf16 v[16:19], v[180:183], v[152:155], v[16:19]
    ds_read_b64_tr_b16 v[220:221], v1 offset:16384
    v_mfma_f32_16x16x32_bf16 v[16:19], v[184:187], v[196:199], v[16:19]
    ds_read_b64_tr_b16 v[222:223], v1 offset:16896
    v_mfma_f32_16x16x32_bf16 v[20:23], v[180:183], v[156:159], v[20:23]
    ds_read_b64_tr_b16 v[224:225], v1 offset:17408
    v_mfma_f32_16x16x32_bf16 v[20:23], v[184:187], v[200:203], v[20:23]
    ds_read_b64_tr_b16 v[226:227], v1 offset:17920
    v_mfma_f32_16x16x32_bf16 v[24:27], v[180:183], v[168:171], v[24:27]
    s_waitcnt lgkmcnt(4)
    v_mfma_f32_16x16x32_bf16 v[24:27], v[184:187], v[204:207], v[24:27]
    v_mfma_f32_16x16x32_bf16 v[28:31], v[180:183], v[172:175], v[28:31]
    v_mfma_f32_16x16x32_bf16 v[28:31], v[184:187], v[208:211], v[28:31]
    v_mfma_f32_16x16x32_bf16 v[32:35], v[180:183], v[212:215], v[32:35]
    v_mfma_f32_16x16x32_bf16 v[32:35], v[184:187], v[216:219], v[32:35]
    s_waitcnt lgkmcnt(0)
    ds_read_b128 v[228:231], v2 offset:2176
    v_mfma_f32_16x16x32_bf16 v[4:7], v[220:223], v[188:191], v[4:7]
    ds_read_b128 v[232:235], v2 offset:2304
    v_mfma_f32_16x16x32_bf16 v[4:7], v[224:227], v[192:195], v[4:7]
    s_barrier
    v_mfma_f32_16x16x32_bf16 v[8:11], v[220:223], v[192:195], v[8:11]
    ds_read_b64_tr_b16 v[236:237], v1 offset:18432
    v_mfma_f32_16x16x32_bf16 v[8:11], v[224:227], v[196:199], v[8:11]
    ds_read_b64_tr_b16 v[238:239], v1 offset:18944
    v_mfma_f32_16x16x32_bf16 v[20:23], v[220:223], v[204:207], v[20:23]
    ds_read_b64_tr_b16 v[240:241], v1 offset:19456
    v_mfma_f32_16x16x32_bf16 v[20:23], v[224:227], v[208:211], v[20:23]
    ds_read_b64_tr_b16 v[242:243], v1 offset:19968
    v_mfma_f32_16x16x32_bf16 v[24:27], v[220:223], v[208:211], v[24:27]
    v_mfma_f32_16x16x32_bf16 v[24:27], v[224:227], v[216:219], v[24:27]
    v_mfma_f32_16x16x32_bf16 v[28:31], v[220:223], v[216:219], v[28:31]
    s_waitcnt lgkmcnt(2)
    v_mfma_f32_16x16x32_bf16 v[28:31], v[224:227], v[228:231], v[28:31]
    v_mfma_f32_16x16x32_bf16 v[32:35], v[220:223], v[228:231], v[32:35]
    v_mfma_f32_16x16x32_bf16 v[32:35], v[224:227], v[232:235], v[32:35]
    ds_read_b128 v[244:247], v2 offset:2432
    v_mfma_f32_16x16x32_bf16 v[4:7], v[236:239], v[196:199], v[4:7]
    s_waitcnt lgkmcnt(1)
    ds_read_b128 v[248:251], v2 offset:2560
    v_mfma_f32_16x16x32_bf16 v[4:7], v[240:243], v[200:203], v[4:7]
    s_barrier
    v_mfma_f32_16x16x32_bf16 v[8:11], v[236:239], v[200:203], v[8:11]
    ds_read_b64_tr_b16 v[252:253], v1 offset:20480
    v_mfma_f32_16x16x32_bf16 v[8:11], v[240:243], v[204:207], v[8:11]
    ds_read_b64_tr_b16 v[254:255], v1 offset:20992
L_pad1_1:
    s_cbranch_execz L_pad1_4
    v_mfma_f32_16x16x32_bf16 v[20:23], v[236:239], v[216:219], v[20:23]
    ds_read_b64_tr_b16 v[40:41], v1 offset:21504
    v_mfma_f32_16x16x32_bf16 v[20:23], v[240:243], v[228:231], v[20:23]
    ds_read_b64_tr_b16 v[42:43], v1 offset:22016
    v_mfma_f32_16x16x32_bf16 v[24:27], v[236:239], v[228:231], v[24:27]
    v_mfma_f32_16x16x32_bf16 v[24:27], v[240:243], v[232:235], v[24:27]
    v_mfma_f32_16x16x32_bf16 v[28:31], v[236:239], v[232:235], v[28:31]
    s_waitcnt lgkmcnt(2)
    v_mfma_f32_16x16x32_bf16 v[28:31], v[240:243], v[244:247], v[28:31]
    v_mfma_f32_16x16x32_bf16 v[32:35], v[236:239], v[244:247], v[32:35]
    v_mfma_f32_16x16x32_bf16 v[32:35], v[240:243], v[248:251], v[32:35]
    ds_read_b128 v[36:39], v2 offset:2688
    v_mfma_f32_16x16x32_bf16 v[4:7], v[252:255], v[204:207], v[4:7]
    s_waitcnt lgkmcnt(1)
    ds_read_b128 v[44:47], v2 offset:2816
    v_mfma_f32_16x16x32_bf16 v[4:7], v[40:43], v[208:211], v[4:7]
    s_barrier
    v_mfma_f32_16x16x32_bf16 v[8:11], v[252:255], v[208:211], v[8:11]
    ds_read_b64_tr_b16 v[72:73], v1 offset:22528
    v_mfma_f32_16x16x32_bf16 v[8:11], v[40:43], v[216:219], v[8:11]
    ds_read_b64_tr_b16 v[74:75], v1 offset:23040
    v_mfma_f32_16x16x32_bf16 v[20:23], v[252:255], v[232:235], v[20:23]
    ds_read_b64_tr_b16 v[48:49], v1 offset:23552
    v_mfma_f32_16x16x32_bf16 v[20:23], v[40:43], v[244:247], v[20:23]
    ds_read_b64_tr_b16 v[50:51], v1 offset:24064
    v_mfma_f32_16x16x32_bf16 v[24:27], v[252:255], v[244:247], v[24:27]
    v_mfma_f32_16x16x32_bf16 v[24:27], v[40:43], v[248:251], v[24:27]
    v_mfma_f32_16x16x32_bf16 v[28:31], v[252:255], v[248:251], v[28:31]
    s_waitcnt lgkmcnt(2)
    v_mfma_f32_16x16x32_bf16 v[28:31], v[40:43], v[36:39], v[28:31]
    v_mfma_f32_16x16x32_bf16 v[32:35], v[252:255], v[36:39], v[32:35]
    v_mfma_f32_16x16x32_bf16 v[32:35], v[40:43], v[44:47], v[32:35]
    ds_read_b128 v[80:83], v2 offset:2944
    v_mfma_f32_16x16x32_bf16 v[4:7], v[72:75], v[216:219], v[4:7]
    s_waitcnt lgkmcnt(1)
    ds_read_b128 v[52:55], v2 offset:3072
    v_mfma_f32_16x16x32_bf16 v[4:7], v[48:51], v[228:231], v[4:7]
    s_barrier
    v_mfma_f32_16x16x32_bf16 v[8:11], v[72:75], v[228:231], v[8:11]
    ds_read_b64_tr_b16 v[88:89], v1 offset:0
    v_mfma_f32_16x16x32_bf16 v[8:11], v[48:51], v[232:235], v[8:11]
    ds_read_b64_tr_b16 v[90:91], v1 offset:512
    v_mfma_f32_16x16x32_bf16 v[20:23], v[72:75], v[248:251], v[20:23]
    ds_read_b64_tr_b16 v[56:57], v1 offset:1024
    v_mfma_f32_16x16x32_bf16 v[20:23], v[48:51], v[36:39], v[20:23]
    ds_read_b64_tr_b16 v[58:59], v1 offset:1536
    v_mfma_f32_16x16x32_bf16 v[24:27], v[72:75], v[36:39], v[24:27]
    v_mfma_f32_16x16x32_bf16 v[24:27], v[48:51], v[44:47], v[24:27]
    v_mfma_f32_16x16x32_bf16 v[28:31], v[72:75], v[44:47], v[28:31]
    s_waitcnt lgkmcnt(2)
    v_mfma_f32_16x16x32_bf16 v[28:31], v[48:51], v[80:83], v[28:31]
    v_mfma_f32_16x16x32_bf16 v[32:35], v[72:75], v[80:83], v[32:35]
    v_mfma_f32_16x16x32_bf16 v[32:35], v[48:51], v[52:55], v[32:35]
    ds_read_b128 v[60:63], v2 offset:4288
    v_mfma_f32_16x16x32_bf16 v[4:7], v[88:91], v[232:235], v[4:7]
    s_waitcnt lgkmcnt(1)
    ds_read_b128 v[96:99], v2 offset:4416
    v_mfma_f32_16x16x32_bf16 v[4:7], v[56:59], v[244:247], v[4:7]
    s_barrier
    v_mfma_f32_16x16x32_bf16 v[8:11], v[88:91], v[244:247], v[8:11]
    ds_read_b64_tr_b16 v[100:101], v1 offset:2048
    v_mfma_f32_16x16x32_bf16 v[8:11], v[56:59], v[248:251], v[8:11]
    ds_read_b64_tr_b16 v[102:103], v1 offset:2560
    v_mfma_f32_16x16x32_bf16 v[20:23], v[88:91], v[44:47], v[20:23]
    ds_read_b64_tr_b16 v[64:65], v1 offset:3072
    v_mfma_f32_16x16x32_bf16 v[20:23], v[56:59], v[80:83], v[20:23]
    ds_read_b64_tr_b16 v[66:67], v1 offset:3584
    v_mfma_f32_16x16x32_bf16 v[24:27], v[88:91], v[80:83], v[24:27]
    v_mfma_f32_16x16x32_bf16 v[24:27], v[56:59], v[52:55], v[24:27]
    v_mfma_f32_16x16x32_bf16 v[28:31], v[88:91], v[52:55], v[28:31]
    s_waitcnt lgkmcnt(2)
    v_mfma_f32_16x16x32_bf16 v[28:31], v[56:59], v[60:63], v[28:31]
    v_mfma_f32_16x16x32_bf16 v[32:35], v[88:91], v[60:63], v[32:35]
    ds_read_b128 v[68:71], v2 offset:4544
    v_mfma_f32_16x16x32_bf16 v[32:35], v[56:59], v[96:99], v[32:35]
    ds_read_b128 v[112:115], v2 offset:4672
    v_mfma_f32_16x16x32_bf16 v[4:7], v[100:103], v[248:251], v[4:7]
    s_waitcnt lgkmcnt(2)
    ds_read_b128 v[116:119], v2 offset:4800
    v_mfma_f32_16x16x32_bf16 v[4:7], v[64:67], v[36:39], v[4:7]
    s_barrier
    v_mfma_f32_16x16x32_bf16 v[8:11], v[100:103], v[36:39], v[8:11]
    ds_read_b64_tr_b16 v[76:77], v1 offset:4096
    v_mfma_f32_16x16x32_bf16 v[8:11], v[64:67], v[44:47], v[8:11]
    ds_read_b64_tr_b16 v[78:79], v1 offset:4608
    v_mfma_f32_16x16x32_bf16 v[20:23], v[100:103], v[52:55], v[20:23]
    ds_read_b64_tr_b16 v[84:85], v1 offset:5120
    v_mfma_f32_16x16x32_bf16 v[20:23], v[64:67], v[60:63], v[20:23]
    ds_read_b64_tr_b16 v[86:87], v1 offset:5632
    v_mfma_f32_16x16x32_bf16 v[24:27], v[100:103], v[60:63], v[24:27]
    v_mfma_f32_16x16x32_bf16 v[24:27], v[64:67], v[96:99], v[24:27]
    ds_read_b128 v[128:131], v2 offset:4928
    v_mfma_f32_16x16x32_bf16 v[28:31], v[100:103], v[96:99], v[28:31]
    s_waitcnt lgkmcnt(3)
    ds_read_b128 v[132:135], v2 offset:21120
    v_mfma_f32_16x16x32_bf16 v[28:31], v[64:67], v[68:71], v[28:31]
    v_mfma_f32_16x16x32_bf16 v[32:35], v[100:103], v[68:71], v[32:35]
    ds_read_b128 v[92:95], v2 offset:21248
    v_mfma_f32_16x16x32_bf16 v[32:35], v[64:67], v[112:115], v[32:35]
    ds_read_b128 v[104:107], v2 offset:21376
    v_mfma_f32_16x16x32_bf16 v[4:7], v[76:79], v[44:47], v[4:7]
    s_waitcnt lgkmcnt(3)
    ds_read_b128 v[144:147], v2 offset:21632
    v_mfma_f32_16x16x32_bf16 v[4:7], v[84:87], v[80:83], v[4:7]
    s_barrier
    v_mfma_f32_16x16x32_bf16 v[8:11], v[76:79], v[80:83], v[8:11]
    ds_read_b64_tr_b16 v[148:149], v1 offset:6144
    v_mfma_f32_16x16x32_bf16 v[8:11], v[84:87], v[52:55], v[8:11]
    ds_read_b64_tr_b16 v[150:151], v1 offset:6656
    v_mfma_f32_16x16x32_bf16 v[20:23], v[76:79], v[96:99], v[20:23]
    ds_read_b64_tr_b16 v[108:109], v1 offset:7168
    v_mfma_f32_16x16x32_bf16 v[20:23], v[84:87], v[68:71], v[20:23]
    ds_read_b64_tr_b16 v[110:111], v1 offset:7680
    v_mfma_f32_16x16x32_bf16 v[24:27], v[76:79], v[68:71], v[24:27]
    v_mfma_f32_16x16x32_bf16 v[24:27], v[84:87], v[112:115], v[24:27]
    ds_read_b128 v[120:123], v2 offset:21760
    v_mfma_f32_16x16x32_bf16 v[28:31], v[76:79], v[112:115], v[28:31]
    ds_read_b128 v[160:163], v2 offset:21888
    v_mfma_f32_16x16x32_bf16 v[28:31], v[84:87], v[116:119], v[28:31]
    v_mfma_f32_16x16x32_bf16 v[32:35], v[76:79], v[116:119], v[32:35]
    ds_read_b128 v[164:167], v2 offset:22016
    v_mfma_f32_16x16x32_bf16 v[32:35], v[84:87], v[128:131], v[32:35]
    s_waitcnt lgkmcnt(3)
    ds_read_b128 v[124:127], v2 offset:23232
    v_mfma_f32_16x16x32_bf16 v[4:7], v[148:151], v[132:135], v[4:7]
    ds_read_b128 v[176:179], v2 offset:21504
    v_mfma_f32_16x16x32_bf16 v[4:7], v[108:111], v[92:95], v[4:7]
    s_barrier
    v_mfma_f32_16x16x32_bf16 v[8:11], v[148:151], v[92:95], v[8:11]
    ds_read_b64_tr_b16 v[136:137], v1 offset:8192
    v_mfma_f32_16x16x32_bf16 v[8:11], v[108:111], v[104:107], v[8:11]
    ds_read_b64_tr_b16 v[138:139], v1 offset:8704
    v_mfma_f32_16x16x32_bf16 v[20:23], v[148:151], v[144:147], v[20:23]
    s_waitcnt lgkmcnt(3)
    ds_read_b64_tr_b16 v[140:141], v1 offset:9216
    v_mfma_f32_16x16x32_bf16 v[20:23], v[108:111], v[120:123], v[20:23]
L_pad1_2:
    s_cbranch_execz L_pad1_5
    ds_read_b64_tr_b16 v[142:143], v1 offset:9728
    v_mfma_f32_16x16x32_bf16 v[24:27], v[148:151], v[120:123], v[24:27]
    v_mfma_f32_16x16x32_bf16 v[24:27], v[108:111], v[160:163], v[24:27]
    v_mfma_f32_16x16x32_bf16 v[28:31], v[148:151], v[160:163], v[28:31]
    v_mfma_f32_16x16x32_bf16 v[28:31], v[108:111], v[164:167], v[28:31]
    v_mfma_f32_16x16x32_bf16 v[32:35], v[148:151], v[164:167], v[32:35]
    v_mfma_f32_16x16x32_bf16 v[32:35], v[108:111], v[124:127], v[32:35]
    s_waitcnt lgkmcnt(0)
    ds_read_b128 v[152:155], v2 offset:23360
    v_mfma_f32_16x16x32_bf16 v[4:7], v[136:139], v[104:107], v[4:7]
    ds_read_b128 v[156:159], v2 offset:23488
    v_mfma_f32_16x16x32_bf16 v[4:7], v[140:143], v[176:179], v[4:7]
    s_barrier
    v_mfma_f32_16x16x32_bf16 v[8:11], v[136:139], v[176:179], v[8:11]
    ds_read_b64_tr_b16 v[168:169], v1 offset:10240
    v_mfma_f32_16x16x32_bf16 v[8:11], v[140:143], v[144:147], v[8:11]
    ds_read_b64_tr_b16 v[170:171], v1 offset:10752
    v_mfma_f32_16x16x32_bf16 v[20:23], v[136:139], v[160:163], v[20:23]
    ds_read_b64_tr_b16 v[172:173], v1 offset:11264
    v_mfma_f32_16x16x32_bf16 v[20:23], v[140:143], v[164:167], v[20:23]
    ds_read_b64_tr_b16 v[174:175], v1 offset:11776
    v_mfma_f32_16x16x32_bf16 v[24:27], v[136:139], v[164:167], v[24:27]
    v_mfma_f32_16x16x32_bf16 v[24:27], v[140:143], v[124:127], v[24:27]
    v_mfma_f32_16x16x32_bf16 v[28:31], v[136:139], v[124:127], v[28:31]
    s_waitcnt lgkmcnt(2)
    v_mfma_f32_16x16x32_bf16 v[28:31], v[140:143], v[152:155], v[28:31]
    v_mfma_f32_16x16x32_bf16 v[32:35], v[136:139], v[152:155], v[32:35]
    v_mfma_f32_16x16x32_bf16 v[32:35], v[140:143], v[156:159], v[32:35]
    ds_read_b128 v[180:183], v2 offset:23616
    v_mfma_f32_16x16x32_bf16 v[4:7], v[168:171], v[144:147], v[4:7]
    s_waitcnt lgkmcnt(1)
    ds_read_b128 v[212:215], v2 offset:23744
    v_mfma_f32_16x16x32_bf16 v[4:7], v[172:175], v[120:123], v[4:7]
    s_barrier
    v_mfma_f32_16x16x32_bf16 v[8:11], v[168:171], v[120:123], v[8:11]
    ds_read_b64_tr_b16 v[184:185], v1 offset:12288
    v_mfma_f32_16x16x32_bf16 v[8:11], v[172:175], v[160:163], v[8:11]
    ds_read_b64_tr_b16 v[186:187], v1 offset:12800
    v_mfma_f32_16x16x32_bf16 v[20:23], v[168:171], v[124:127], v[20:23]
    ds_read_b64_tr_b16 v[188:189], v1 offset:13312
    v_mfma_f32_16x16x32_bf16 v[20:23], v[172:175], v[152:155], v[20:23]
    ds_read_b64_tr_b16 v[190:191], v1 offset:13824
    v_mfma_f32_16x16x32_bf16 v[24:27], v[168:171], v[152:155], v[24:27]
    v_mfma_f32_16x16x32_bf16 v[24:27], v[172:175], v[156:159], v[24:27]
    v_mfma_f32_16x16x32_bf16 v[28:31], v[168:171], v[156:159], v[28:31]
    s_waitcnt lgkmcnt(2)
    v_mfma_f32_16x16x32_bf16 v[28:31], v[172:175], v[180:183], v[28:31]
    v_mfma_f32_16x16x32_bf16 v[32:35], v[168:171], v[180:183], v[32:35]
    v_mfma_f32_16x16x32_bf16 v[32:35], v[172:175], v[212:215], v[32:35]
    ds_read_b128 v[192:195], v2 offset:23872
    v_mfma_f32_16x16x32_bf16 v[4:7], v[184:187], v[160:163], v[4:7]
    s_waitcnt lgkmcnt(1)
    ds_read_b128 v[196:199], v2 offset:24000
    v_mfma_f32_16x16x32_bf16 v[4:7], v[188:191], v[164:167], v[4:7]
    s_barrier
    v_mfma_f32_16x16x32_bf16 v[8:11], v[184:187], v[164:167], v[8:11]
    ds_read_b64_tr_b16 v[200:201], v1 offset:14336
    v_mfma_f32_16x16x32_bf16 v[8:11], v[188:191], v[124:127], v[8:11]
    ds_read_b64_tr_b16 v[202:203], v1 offset:14848
    v_mfma_f32_16x16x32_bf16 v[20:23], v[184:187], v[156:159], v[20:23]
    ds_read_b64_tr_b16 v[204:205], v1 offset:15360
    v_mfma_f32_16x16x32_bf16 v[20:23], v[188:191], v[180:183], v[20:23]
    ds_read_b64_tr_b16 v[206:207], v1 offset:15872
    v_mfma_f32_16x16x32_bf16 v[24:27], v[184:187], v[180:183], v[24:27]
    v_mfma_f32_16x16x32_bf16 v[24:27], v[188:191], v[212:215], v[24:27]
    v_mfma_f32_16x16x32_bf16 v[28:31], v[184:187], v[212:215], v[28:31]
    s_waitcnt lgkmcnt(2)
    v_mfma_f32_16x16x32_bf16 v[28:31], v[188:191], v[192:195], v[28:31]
    v_mfma_f32_16x16x32_bf16 v[32:35], v[184:187], v[192:195], v[32:35]
    v_mfma_f32_16x16x32_bf16 v[32:35], v[188:191], v[196:199], v[32:35]
    ds_read_b128 v[208:211], v2 offset:24128
    v_mfma_f32_16x16x32_bf16 v[4:7], v[200:203], v[124:127], v[4:7]
    s_waitcnt lgkmcnt(1)
    ds_read_b128 v[216:219], v2 offset:25344
    v_mfma_f32_16x16x32_bf16 v[4:7], v[204:207], v[152:155], v[4:7]
    s_barrier
    v_mfma_f32_16x16x32_bf16 v[8:11], v[200:203], v[152:155], v[8:11]
    ds_read_b64_tr_b16 v[228:229], v1 offset:16384
    v_mfma_f32_16x16x32_bf16 v[8:11], v[204:207], v[156:159], v[8:11]
    ds_read_b64_tr_b16 v[230:231], v1 offset:16896
    v_mfma_f32_16x16x32_bf16 v[20:23], v[200:203], v[212:215], v[20:23]
    ds_read_b64_tr_b16 v[232:233], v1 offset:17408
    v_mfma_f32_16x16x32_bf16 v[20:23], v[204:207], v[192:195], v[20:23]
    ds_read_b64_tr_b16 v[234:235], v1 offset:17920
    v_mfma_f32_16x16x32_bf16 v[24:27], v[200:203], v[192:195], v[24:27]
    v_mfma_f32_16x16x32_bf16 v[24:27], v[204:207], v[196:199], v[24:27]
    v_mfma_f32_16x16x32_bf16 v[28:31], v[200:203], v[196:199], v[28:31]
    s_waitcnt lgkmcnt(2)
    v_mfma_f32_16x16x32_bf16 v[28:31], v[204:207], v[208:211], v[28:31]
    v_mfma_f32_16x16x32_bf16 v[32:35], v[200:203], v[208:211], v[32:35]
    ds_read_b128 v[244:247], v2 offset:25472
    v_mfma_f32_16x16x32_bf16 v[32:35], v[204:207], v[216:219], v[32:35]
    ds_read_b128 v[248:251], v2 offset:25600
    v_mfma_f32_16x16x32_bf16 v[4:7], v[228:231], v[156:159], v[4:7]
    s_waitcnt lgkmcnt(2)
    ds_read_b128 v[36:39], v2 offset:25728
    v_mfma_f32_16x16x32_bf16 v[4:7], v[232:235], v[180:183], v[4:7]
    s_barrier
    v_mfma_f32_16x16x32_bf16 v[8:11], v[228:231], v[180:183], v[8:11]
    ds_read_b64_tr_b16 v[60:61], v1 offset:18432
    v_mfma_f32_16x16x32_bf16 v[8:11], v[232:235], v[212:215], v[8:11]
    ds_read_b64_tr_b16 v[62:63], v1 offset:18944
    v_mfma_f32_16x16x32_bf16 v[20:23], v[228:231], v[196:199], v[20:23]
    ds_read_b64_tr_b16 v[44:45], v1 offset:19456
    v_mfma_f32_16x16x32_bf16 v[20:23], v[232:235], v[208:211], v[20:23]
    ds_read_b64_tr_b16 v[46:47], v1 offset:19968
    v_mfma_f32_16x16x32_bf16 v[24:27], v[228:231], v[208:211], v[24:27]
    v_mfma_f32_16x16x32_bf16 v[24:27], v[232:235], v[216:219], v[24:27]
    ds_read_b128 v[80:83], v2 offset:25856
    v_mfma_f32_16x16x32_bf16 v[28:31], v[228:231], v[216:219], v[28:31]
    s_waitcnt lgkmcnt(3)
    ds_read_b128 v[52:55], v2 offset:21184
    v_mfma_f32_16x16x32_bf16 v[28:31], v[232:235], v[244:247], v[28:31]
    v_mfma_f32_16x16x32_bf16 v[32:35], v[228:231], v[244:247], v[32:35]
    ds_read_b128 v[96:99], v2 offset:21312
    v_mfma_f32_16x16x32_bf16 v[32:35], v[232:235], v[248:251], v[32:35]
    ds_read_b128 v[68:71], v2 offset:21696
    v_mfma_f32_16x16x32_bf16 v[4:7], v[60:63], v[212:215], v[4:7]
    s_waitcnt lgkmcnt(3)
    ds_read_b128 v[112:115], v2 offset:21824
    v_mfma_f32_16x16x32_bf16 v[4:7], v[44:47], v[192:195], v[4:7]
    s_barrier
    v_mfma_f32_16x16x32_bf16 v[8:11], v[60:63], v[192:195], v[8:11]
    ds_read_b64_tr_b16 v[116:117], v1 offset:20480
    v_mfma_f32_16x16x32_bf16 v[8:11], v[44:47], v[196:199], v[8:11]
    ds_read_b64_tr_b16 v[118:119], v1 offset:20992
    v_mfma_f32_16x16x32_bf16 v[20:23], v[60:63], v[216:219], v[20:23]
    ds_read_b64_tr_b16 v[128:129], v1 offset:21504
    v_mfma_f32_16x16x32_bf16 v[20:23], v[44:47], v[244:247], v[20:23]
    ds_read_b64_tr_b16 v[130:131], v1 offset:22016
    v_mfma_f32_16x16x32_bf16 v[24:27], v[60:63], v[244:247], v[24:27]
L_pad1_3:
    s_cbranch_execz L_main1
    v_mfma_f32_16x16x32_bf16 v[24:27], v[44:47], v[248:251], v[24:27]
    ds_read_b128 v[132:135], v2 offset:21440
    v_mfma_f32_16x16x32_bf16 v[28:31], v[60:63], v[248:251], v[28:31]
    ds_read_b128 v[92:95], v2 offset:21568
    v_mfma_f32_16x16x32_bf16 v[28:31], v[44:47], v[36:39], v[28:31]
    s_barrier
    v_mfma_f32_16x16x32_bf16 v[32:35], v[60:63], v[36:39], v[32:35]
    ds_read_b64_tr_b16 v[104:105], v1 offset:22528
    v_mfma_f32_16x16x32_bf16 v[32:35], v[44:47], v[80:83], v[32:35]
    s_waitcnt lgkmcnt(3)
    ds_read_b64_tr_b16 v[106:107], v1 offset:23040
    v_mfma_f32_16x16x32_bf16 v[4:7], v[116:119], v[196:199], v[4:7]
    ds_read_b64_tr_b16 v[176:177], v1 offset:23552
    v_mfma_f32_16x16x32_bf16 v[4:7], v[128:131], v[52:55], v[4:7]
    ds_read_b64_tr_b16 v[178:179], v1 offset:24064
    v_mfma_f32_16x16x32_bf16 v[8:11], v[116:119], v[208:211], v[8:11]
    v_mfma_f32_16x16x32_bf16 v[8:11], v[128:131], v[96:99], v[8:11]
    ds_read_b128 v[144:147], v2 offset:21952
    v_mfma_f32_16x16x32_bf16 v[20:23], v[116:119], v[248:251], v[20:23]
    ds_read_b128 v[120:123], v2 offset:22080
    v_mfma_f32_16x16x32_bf16 v[20:23], v[128:131], v[68:71], v[20:23]
    s_barrier
    v_mfma_f32_16x16x32_bf16 v[24:27], v[116:119], v[36:39], v[24:27]
    ds_read_b64_tr_b16 v[160:161], v1 offset:0
    v_mfma_f32_16x16x32_bf16 v[24:27], v[128:131], v[112:115], v[24:27]
    s_waitcnt lgkmcnt(3)
    ds_read_b64_tr_b16 v[162:163], v1 offset:512
    v_mfma_f32_16x16x32_bf16 v[4:7], v[104:107], v[96:99], v[4:7]
    ds_read_b64_tr_b16 v[164:165], v1 offset:1024
    v_mfma_f32_16x16x32_bf16 v[4:7], v[176:179], v[132:135], v[4:7]
    ds_read_b64_tr_b16 v[166:167], v1 offset:1536
    v_mfma_f32_16x16x32_bf16 v[8:11], v[104:107], v[132:135], v[8:11]
    v_mfma_f32_16x16x32_bf16 v[8:11], v[176:179], v[92:95], v[8:11]
    ds_read_b128 v[124:127], v2 offset:23296
    v_mfma_f32_16x16x32_bf16 v[20:23], v[104:107], v[112:115], v[20:23]
    s_waitcnt lgkmcnt(3)
    ds_read_b128 v[152:155], v2 offset:23424
    v_mfma_f32_16x16x32_bf16 v[20:23], v[176:179], v[144:147], v[20:23]
    s_barrier
    v_mfma_f32_16x16x32_bf16 v[24:27], v[104:107], v[144:147], v[24:27]
    ds_read_b64_tr_b16 v[156:157], v1 offset:2048
    v_mfma_f32_16x16x32_bf16 v[24:27], v[176:179], v[120:123], v[24:27]
    ds_read_b64_tr_b16 v[158:159], v1 offset:2560
    v_mfma_f32_16x16x32_bf16 v[4:7], v[160:163], v[92:95], v[4:7]
    s_waitcnt lgkmcnt(3)
    ds_read_b64_tr_b16 v[180:181], v1 offset:3072
    v_mfma_f32_16x16x32_bf16 v[4:7], v[164:167], v[68:71], v[4:7]
    ds_read_b64_tr_b16 v[182:183], v1 offset:3584
    v_mfma_f32_16x16x32_bf16 v[8:11], v[160:163], v[68:71], v[8:11]
    v_mfma_f32_16x16x32_bf16 v[8:11], v[164:167], v[112:115], v[8:11]
    ds_read_b128 v[212:215], v2 offset:23552
    v_mfma_f32_16x16x32_bf16 v[20:23], v[160:163], v[120:123], v[20:23]
    ds_read_b128 v[192:195], v2 offset:23680
    v_mfma_f32_16x16x32_bf16 v[20:23], v[164:167], v[124:127], v[20:23]
    s_barrier
    v_mfma_f32_16x16x32_bf16 v[24:27], v[160:163], v[124:127], v[24:27]
    s_waitcnt lgkmcnt(2)
    ds_read_b64_tr_b16 v[216:217], v1 offset:4096
    v_mfma_f32_16x16x32_bf16 v[24:27], v[164:167], v[152:155], v[24:27]
    ds_read_b64_tr_b16 v[218:219], v1 offset:4608
    v_mfma_f32_16x16x32_bf16 v[4:7], v[156:159], v[112:115], v[4:7]
    ds_read_b64_tr_b16 v[244:245], v1 offset:5120
    v_mfma_f32_16x16x32_bf16 v[4:7], v[180:183], v[144:147], v[4:7]
    ds_read_b64_tr_b16 v[246:247], v1 offset:5632
    v_mfma_f32_16x16x32_bf16 v[8:11], v[156:159], v[144:147], v[8:11]
    v_mfma_f32_16x16x32_bf16 v[8:11], v[180:183], v[120:123], v[8:11]
    ds_read_b128 v[80:83], v2 offset:23808
    v_mfma_f32_16x16x32_bf16 v[20:23], v[156:159], v[152:155], v[20:23]
    s_waitcnt lgkmcnt(3)
    ds_read_b128 v[196:199], v2 offset:23936
    v_mfma_f32_16x16x32_bf16 v[20:23], v[180:183], v[212:215], v[20:23]
    s_barrier
    v_mfma_f32_16x16x32_bf16 v[24:27], v[156:159], v[212:215], v[24:27]
    ds_read_b64_tr_b16 v[52:53], v1 offset:6144
    v_mfma_f32_16x16x32_bf16 v[24:27], v[180:183], v[192:195], v[24:27]
    ds_read_b64_tr_b16 v[54:55], v1 offset:6656
    v_mfma_f32_16x16x32_bf16 v[4:7], v[216:219], v[120:123], v[4:7]
    s_waitcnt lgkmcnt(3)
    ds_read_b64_tr_b16 v[208:209], v1 offset:7168
    v_mfma_f32_16x16x32_bf16 v[4:7], v[244:247], v[124:127], v[4:7]
    ds_read_b64_tr_b16 v[210:211], v1 offset:7680
    v_mfma_f32_16x16x32_bf16 v[8:11], v[216:219], v[124:127], v[8:11]
    v_mfma_f32_16x16x32_bf16 v[8:11], v[244:247], v[152:155], v[8:11]
    ds_read_b128 v[248:251], v2 offset:24064
    v_mfma_f32_16x16x32_bf16 v[20:23], v[216:219], v[192:195], v[20:23]
    ds_read_b128 v[36:39], v2 offset:24192
    v_mfma_f32_16x16x32_bf16 v[20:23], v[244:247], v[80:83], v[20:23]
    s_barrier
    v_mfma_f32_16x16x32_bf16 v[24:27], v[216:219], v[80:83], v[24:27]
    s_waitcnt lgkmcnt(2)
    ds_read_b64_tr_b16 v[96:97], v1 offset:8192
    v_mfma_f32_16x16x32_bf16 v[24:27], v[244:247], v[196:199], v[24:27]
    ds_read_b64_tr_b16 v[98:99], v1 offset:8704
    v_mfma_f32_16x16x32_bf16 v[4:7], v[52:55], v[152:155], v[4:7]
    ds_read_b64_tr_b16 v[132:133], v1 offset:9216
    v_mfma_f32_16x16x32_bf16 v[4:7], v[208:211], v[212:215], v[4:7]
    ds_read_b64_tr_b16 v[134:135], v1 offset:9728
    v_mfma_f32_16x16x32_bf16 v[8:11], v[52:55], v[212:215], v[8:11]
    v_mfma_f32_16x16x32_bf16 v[8:11], v[208:211], v[192:195], v[8:11]
    ds_read_b128 v[92:95], v2 offset:25408
    v_mfma_f32_16x16x32_bf16 v[20:23], v[52:55], v[196:199], v[20:23]
    s_waitcnt lgkmcnt(3)
    ds_read_b128 v[68:71], v2 offset:25536
    v_mfma_f32_16x16x32_bf16 v[20:23], v[208:211], v[248:251], v[20:23]
    s_barrier
    v_mfma_f32_16x16x32_bf16 v[24:27], v[52:55], v[248:251], v[24:27]
    ds_read_b64_tr_b16 v[112:113], v1 offset:10240
    v_mfma_f32_16x16x32_bf16 v[24:27], v[208:211], v[36:39], v[24:27]
    ds_read_b64_tr_b16 v[114:115], v1 offset:10752
    v_mfma_f32_16x16x32_bf16 v[4:7], v[96:99], v[192:195], v[4:7]
    s_waitcnt lgkmcnt(3)
    ds_read_b64_tr_b16 v[144:145], v1 offset:11264
    v_mfma_f32_16x16x32_bf16 v[4:7], v[132:135], v[80:83], v[4:7]
    ds_read_b64_tr_b16 v[146:147], v1 offset:11776
    v_mfma_f32_16x16x32_bf16 v[8:11], v[96:99], v[80:83], v[8:11]
    v_mfma_f32_16x16x32_bf16 v[8:11], v[132:135], v[196:199], v[8:11]
    v_mfma_f32_16x16x32_bf16 v[20:23], v[96:99], v[36:39], v[20:23]
    v_mfma_f32_16x16x32_bf16 v[20:23], v[132:135], v[92:95], v[20:23]
    ds_read_b128 v[120:123], v2 offset:25664
    v_mfma_f32_16x16x32_bf16 v[24:27], v[96:99], v[92:95], v[24:27]
    s_waitcnt lgkmcnt(1)
    ds_read_b128 v[124:127], v2 offset:25792
    v_mfma_f32_16x16x32_bf16 v[24:27], v[132:135], v[68:71], v[24:27]
    ds_read_b128 v[152:155], v2 offset:25856
    v_mfma_f32_16x16x32_bf16 v[4:7], v[112:115], v[196:199], v[4:7]
    v_mfma_f32_16x16x32_bf16 v[4:7], v[144:147], v[248:251], v[4:7]
    ds_read_b128 v[212:215], v2 offset:25984
    v_mfma_f32_16x16x32_bf16 v[8:11], v[112:115], v[248:251], v[8:11]
    ds_read_b128 v[192:195], v2 offset:21952
    v_mfma_f32_16x16x32_bf16 v[8:11], v[144:147], v[36:39], v[8:11]
    s_nop 0
    ds_read_b128 v[80:83], v2 offset:22080
    s_nop 0
    v_mfma_f32_16x16x32_bf16 v[20:23], v[112:115], v[68:71], v[20:23]
    s_waitcnt lgkmcnt(3)
    s_nop 1
    v_mfma_f32_16x16x32_bf16 v[20:23], v[144:147], v[120:123], v[20:23]
    ds_read_b128 v[92:95], v2 offset:23296
    v_cvt_pk_bf16_f32 v4, v4, v5
    v_mfma_f32_16x16x32_bf16 v[24:27], v[112:115], v[120:123], v[24:27]
    v_cvt_pk_bf16_f32 v5, v6, v7
    v_cvt_pk_bf16_f32 v6, v8, v9
    v_mfma_f32_16x16x32_bf16 v[24:27], v[144:147], v[124:127], v[24:27]
    ds_read_b128 v[196:199], v2 offset:23424
    v_cvt_pk_bf16_f32 v7, v10, v11
    v_mfma_f32_16x16x32_bf16 v[28:31], v[116:119], v[152:155], v[28:31]
    s_waitcnt lgkmcnt(2)
    v_min_u32 v4, -2, v4
    v_min_u32 v5, -2, v5
    v_mfma_f32_16x16x32_bf16 v[32:35], v[116:119], v[212:215], v[32:35]
    ds_read_b128 v[248:251], v2 offset:23552
    v_min_u32 v6, -2, v6
    v_mfma_f32_16x16x32_bf16 v[28:31], v[128:131], v[192:195], v[28:31]
    v_min_u32 v7, -2, v7
L_pad1_4:
    s_cbranch_execz L_main1
    v_mfma_f32_16x16x32_bf16 v[28:31], v[104:107], v[80:83], v[28:31]
    buffer_store_dwordx4 v[4:7], v3, s[28:31], s40 offen sc1
    ds_read_b128 v[36:39], v2 offset:23680
    v_cvt_pk_bf16_f32 v20, v20, v21
    v_cvt_pk_bf16_f32 v21, v22, v23
    v_cvt_pk_bf16_f32 v22, v24, v25
    v_mfma_f32_16x16x32_bf16 v[32:35], v[128:131], v[80:83], v[32:35]
    s_waitcnt lgkmcnt(2)
    v_cvt_pk_bf16_f32 v23, v26, v27
    v_min_u32 v20, -2, v20
    v_mfma_f32_16x16x32_bf16 v[32:35], v[104:107], v[92:95], v[32:35]
    ds_read_b128 v[68:71], v2 offset:23808
    v_min_u32 v21, -2, v21
    v_mfma_f32_16x16x32_bf16 v[28:31], v[176:179], v[92:95], v[28:31]
    v_min_u32 v22, -2, v22
    v_min_u32 v23, -2, v23
    v_mfma_f32_16x16x32_bf16 v[28:31], v[160:163], v[196:199], v[28:31]
    buffer_store_dwordx4 v[20:23], v3, s[28:31], s42 offen sc1
    ds_read_b128 v[120:123], v2 offset:23936
    v_mfma_f32_16x16x32_bf16 v[32:35], v[176:179], v[196:199], v[32:35]
    s_waitcnt lgkmcnt(2)
    v_mfma_f32_16x16x32_bf16 v[32:35], v[160:163], v[248:251], v[32:35]
    ds_read_b128 v[124:127], v2 offset:24064
    v_mfma_f32_16x16x32_bf16 v[28:31], v[164:167], v[248:251], v[28:31]
    v_mfma_f32_16x16x32_bf16 v[28:31], v[156:159], v[36:39], v[28:31]
    ds_read_b128 v[152:155], v2 offset:24192
    v_mfma_f32_16x16x32_bf16 v[32:35], v[164:167], v[36:39], v[32:35]
    s_waitcnt lgkmcnt(2)
    v_mfma_f32_16x16x32_bf16 v[32:35], v[156:159], v[68:71], v[32:35]
    ds_read_b128 v[212:215], v2 offset:25408
    v_mfma_f32_16x16x32_bf16 v[28:31], v[180:183], v[68:71], v[28:31]
    v_mfma_f32_16x16x32_bf16 v[28:31], v[216:219], v[120:123], v[28:31]
    ds_read_b128 v[192:195], v2 offset:25536
    v_mfma_f32_16x16x32_bf16 v[32:35], v[180:183], v[120:123], v[32:35]
    s_waitcnt lgkmcnt(2)
    v_mfma_f32_16x16x32_bf16 v[32:35], v[216:219], v[124:127], v[32:35]
    ds_read_b128 v[80:83], v2 offset:25664
    v_mfma_f32_16x16x32_bf16 v[28:31], v[244:247], v[124:127], v[28:31]
    v_mfma_f32_16x16x32_bf16 v[28:31], v[52:55], v[152:155], v[28:31]
    ds_read_b128 v[92:95], v2 offset:25792
    v_mfma_f32_16x16x32_bf16 v[32:35], v[244:247], v[152:155], v[32:35]
    s_waitcnt lgkmcnt(2)
    v_mfma_f32_16x16x32_bf16 v[32:35], v[52:55], v[212:215], v[32:35]
    ds_read_b128 v[196:199], v2 offset:25920
    v_mfma_f32_16x16x32_bf16 v[28:31], v[208:211], v[212:215], v[28:31]
    v_mfma_f32_16x16x32_bf16 v[28:31], v[96:99], v[192:195], v[28:31]
    ds_read_b128 v[248:251], v2 offset:26048
    v_mfma_f32_16x16x32_bf16 v[32:35], v[208:211], v[192:195], v[32:35]
    s_waitcnt lgkmcnt(2)
    ds_read_b128 v[36:39], v2 offset:448
    v_mfma_f32_16x16x32_bf16 v[32:35], v[96:99], v[80:83], v[32:35]
    ds_read_b128 v[68:71], v2 offset:576
    v_mfma_f32_16x16x32_bf16 v[28:31], v[132:135], v[80:83], v[28:31]
    v_mfma_f32_16x16x32_bf16 v[28:31], v[112:115], v[92:95], v[28:31]
    ds_read_b128 v[120:123], v2 offset:704
    v_mfma_f32_16x16x32_bf16 v[32:35], v[132:135], v[92:95], v[32:35]
    s_waitcnt lgkmcnt(3)
    v_mfma_f32_16x16x32_bf16 v[32:35], v[112:115], v[196:199], v[32:35]
    ds_read_b128 v[124:127], v2 offset:832
    v_mfma_f32_16x16x32_bf16 v[28:31], v[144:147], v[196:199], v[28:31]
    v_mfma_f32_16x16x32_bf16 v[32:35], v[144:147], v[248:251], v[32:35]
    s_waitcnt lgkmcnt(2)
    ds_read_b128 v[152:155], v2 offset:960
    s_nop 0
    v_mfma_f32_16x16x32_bf16 v[12:15], v[220:223], v[36:39], v[12:15]
    s_nop 0
    s_nop 1
    v_mfma_f32_16x16x32_bf16 v[12:15], v[224:227], v[68:71], v[12:15]
    ds_read_b128 v[212:215], v2 offset:2176
    v_cvt_pk_bf16_f32 v28, v28, v29
    v_mfma_f32_16x16x32_bf16 v[16:19], v[220:223], v[68:71], v[16:19]
    s_waitcnt lgkmcnt(2)
    v_cvt_pk_bf16_f32 v29, v30, v31
    v_cvt_pk_bf16_f32 v30, v32, v33
    v_mfma_f32_16x16x32_bf16 v[16:19], v[224:227], v[120:123], v[16:19]
    ds_read_b128 v[192:195], v2 offset:2304
    v_cvt_pk_bf16_f32 v31, v34, v35
    v_mfma_f32_16x16x32_bf16 v[12:15], v[236:239], v[120:123], v[12:15]
    v_min_u32 v28, -2, v28
    v_min_u32 v29, -2, v29
    v_mfma_f32_16x16x32_bf16 v[12:15], v[240:243], v[124:127], v[12:15]
    ds_read_b128 v[80:83], v2 offset:2432
    v_min_u32 v30, -2, v30
    v_mfma_f32_16x16x32_bf16 v[16:19], v[236:239], v[124:127], v[16:19]
    s_waitcnt lgkmcnt(2)
    v_min_u32 v31, -2, v31
    v_mfma_f32_16x16x32_bf16 v[16:19], v[240:243], v[152:155], v[16:19]
    buffer_store_dwordx4 v[28:31], v3, s[28:31], s43 offen sc1
    ds_read_b128 v[92:95], v2 offset:2560
    v_and_b32 v24, 15, v0
    v_lshrrev_b32 v32, 4, v0
    v_mad_u32_u24 v33, v24, 17, v32
    v_mfma_f32_16x16x32_bf16 v[12:15], v[252:255], v[152:155], v[12:15]
    s_lshl_b32 s12, s10, 6
    s_add_u32 s12, s12, 149248
    v_lshl_add_u32 v33, v33, 4, s12
    v_mfma_f32_16x16x32_bf16 v[12:15], v[40:43], v[212:215], v[12:15]
    ds_read_b128 v[196:199], v2 offset:2688
    v_mad_u32_u24 v34, v32, 17, v24
    v_mfma_f32_16x16x32_bf16 v[16:19], v[252:255], v[212:215], v[16:19]
    s_waitcnt lgkmcnt(2)
    s_mul_i32 s12, s10, 1088
    s_add_u32 s12, s12, 144896
    v_mfma_f32_16x16x32_bf16 v[16:19], v[40:43], v[192:195], v[16:19]
    ds_read_b128 v[248:251], v2 offset:2816
    v_lshl_add_u32 v34, v34, 4, s12
    v_mfma_f32_16x16x32_bf16 v[12:15], v[72:75], v[192:195], v[12:15]
    v_mul_u32_u24 v32, 9, v32
    v_and_b32 v32, 17, v32
    v_mfma_f32_16x16x32_bf16 v[12:15], v[48:51], v[80:83], v[12:15]
    s_lshl2_add_u32 s12, s7, s10
    ds_read_b128 v[36:39], v2 offset:2944
    s_lshl3_add_u32 s12, s12, s4
    v_mfma_f32_16x16x32_bf16 v[16:19], v[72:75], v[80:83], v[16:19]
    s_waitcnt lgkmcnt(2)
    s_lshl4_add_u32 s12, s12, s6
    s_add_u32 s12, s12, 8
    v_mfma_f32_16x16x32_bf16 v[16:19], v[48:51], v[92:95], v[16:19]
    s_lshl_b32 s12, s12, 7
    ds_read_b128 v[220:223], v2 offset:3072
    v_lshl_add_u32 v35, v32, 6, v24
    v_mfma_f32_16x16x32_bf16 v[12:15], v[88:91], v[92:95], v[12:15]
    v_lshl_add_u32 v35, v35, 3, s12
    v_mfma_f32_16x16x32_bf16 v[12:15], v[56:59], v[196:199], v[12:15]
    ds_read_b128 v[68:71], v2 offset:4288
    v_mfma_f32_16x16x32_bf16 v[16:19], v[88:91], v[196:199], v[16:19]
    s_waitcnt lgkmcnt(2)
    ds_read_b128 v[224:227], v2 offset:4416
    v_mfma_f32_16x16x32_bf16 v[16:19], v[56:59], v[248:251], v[16:19]
    v_mfma_f32_16x16x32_bf16 v[12:15], v[100:103], v[248:251], v[12:15]
    ds_read_b128 v[120:123], v2 offset:21376
    v_mfma_f32_16x16x32_bf16 v[12:15], v[64:67], v[36:39], v[12:15]
    ds_read_b128 v[236:239], v2 offset:21504
    v_mfma_f32_16x16x32_bf16 v[16:19], v[100:103], v[36:39], v[16:19]
    s_waitcnt lgkmcnt(3)
    ds_read_b128 v[124:127], v2 offset:21632
    v_mfma_f32_16x16x32_bf16 v[16:19], v[64:67], v[220:223], v[16:19]
    s_barrier
    v_mfma_f32_16x16x32_bf16 v[12:15], v[76:79], v[220:223], v[12:15]
    v_mfma_f32_16x16x32_bf16 v[12:15], v[84:87], v[68:71], v[12:15]
    ds_read_b128 v[240:243], v2 offset:21760
    v_mfma_f32_16x16x32_bf16 v[16:19], v[76:79], v[68:71], v[16:19]
    s_waitcnt lgkmcnt(2)
    v_mfma_f32_16x16x32_bf16 v[16:19], v[84:87], v[224:227], v[16:19]
    ds_read_b128 v[152:155], v2 offset:21888
    v_mfma_f32_16x16x32_bf16 v[12:15], v[148:151], v[120:123], v[12:15]
    v_mfma_f32_16x16x32_bf16 v[12:15], v[108:111], v[236:239], v[12:15]
    ds_read_b128 v[252:255], v2 offset:22016
    v_mfma_f32_16x16x32_bf16 v[16:19], v[148:151], v[236:239], v[16:19]
    s_waitcnt lgkmcnt(2)
    v_mfma_f32_16x16x32_bf16 v[16:19], v[108:111], v[124:127], v[16:19]
    ds_read_b128 v[212:215], v2 offset:23232
    v_mfma_f32_16x16x32_bf16 v[12:15], v[136:139], v[124:127], v[12:15]
L_pad1_5:
    s_cbranch_execz L_main1
    v_mfma_f32_16x16x32_bf16 v[12:15], v[140:143], v[240:243], v[12:15]
    ds_read_b128 v[40:43], v2 offset:23360
    v_mfma_f32_16x16x32_bf16 v[16:19], v[136:139], v[240:243], v[16:19]
    s_waitcnt lgkmcnt(2)
    v_mfma_f32_16x16x32_bf16 v[16:19], v[140:143], v[152:155], v[16:19]
    ds_read_b128 v[192:195], v2 offset:23488
    v_mfma_f32_16x16x32_bf16 v[12:15], v[168:171], v[152:155], v[12:15]
    v_mfma_f32_16x16x32_bf16 v[12:15], v[172:175], v[252:255], v[12:15]
    ds_read_b128 v[72:75], v2 offset:23616
    v_mfma_f32_16x16x32_bf16 v[16:19], v[168:171], v[252:255], v[16:19]
    s_waitcnt lgkmcnt(2)
    v_mfma_f32_16x16x32_bf16 v[16:19], v[172:175], v[212:215], v[16:19]
    ds_read_b128 v[80:83], v2 offset:23744
    v_mfma_f32_16x16x32_bf16 v[12:15], v[184:187], v[212:215], v[12:15]
    v_mfma_f32_16x16x32_bf16 v[12:15], v[188:191], v[40:43], v[12:15]
    ds_read_b128 v[48:51], v2 offset:23872
    v_mfma_f32_16x16x32_bf16 v[16:19], v[184:187], v[40:43], v[16:19]
    s_waitcnt lgkmcnt(2)
    v_mfma_f32_16x16x32_bf16 v[16:19], v[188:191], v[192:195], v[16:19]
    ds_read_b128 v[92:95], v2 offset:24000
    v_mfma_f32_16x16x32_bf16 v[12:15], v[200:203], v[192:195], v[12:15]
    v_mfma_f32_16x16x32_bf16 v[12:15], v[204:207], v[72:75], v[12:15]
    ds_read_b128 v[88:91], v2 offset:24128
    v_mfma_f32_16x16x32_bf16 v[16:19], v[200:203], v[72:75], v[16:19]
    s_waitcnt lgkmcnt(2)
    ds_read_b128 v[196:199], v2 offset:25344
    v_mfma_f32_16x16x32_bf16 v[16:19], v[204:207], v[80:83], v[16:19]
    v_mfma_f32_16x16x32_bf16 v[12:15], v[228:231], v[80:83], v[12:15]
    ds_read_b128 v[56:59], v2 offset:25472
    v_mfma_f32_16x16x32_bf16 v[12:15], v[232:235], v[48:51], v[12:15]
    ds_read_b128 v[248:251], v2 offset:21440
    v_mfma_f32_16x16x32_bf16 v[16:19], v[228:231], v[48:51], v[16:19]
    s_waitcnt lgkmcnt(3)
    ds_read_b128 v[100:103], v2 offset:21568
    v_mfma_f32_16x16x32_bf16 v[16:19], v[232:235], v[92:95], v[16:19]
    buffer_load_dwordx4 v[36:39], v3, s[28:31], s44 offen sc1
    v_mfma_f32_16x16x32_bf16 v[12:15], v[60:63], v[92:95], v[12:15]
    v_mfma_f32_16x16x32_bf16 v[12:15], v[44:47], v[88:91], v[12:15]
    ds_read_b128 v[64:67], v2 offset:21696
    v_mfma_f32_16x16x32_bf16 v[16:19], v[60:63], v[88:91], v[16:19]
    s_waitcnt lgkmcnt(2)
    v_mfma_f32_16x16x32_bf16 v[16:19], v[44:47], v[196:199], v[16:19]
    ds_read_b128 v[220:223], v2 offset:21824
    v_mfma_f32_16x16x32_bf16 v[12:15], v[116:119], v[196:199], v[12:15]
    v_mfma_f32_16x16x32_bf16 v[16:19], v[116:119], v[56:59], v[16:19]
    ds_read_b128 v[76:79], v2 offset:21952
    v_mfma_f32_16x16x32_bf16 v[12:15], v[128:131], v[248:251], v[12:15]
    s_waitcnt lgkmcnt(2)
    v_mfma_f32_16x16x32_bf16 v[12:15], v[104:107], v[100:103], v[12:15]
    ds_read_b128 v[68:71], v2 offset:22080
    v_mfma_f32_16x16x32_bf16 v[16:19], v[128:131], v[100:103], v[16:19]
    v_mfma_f32_16x16x32_bf16 v[16:19], v[104:107], v[64:67], v[16:19]
    ds_read_b128 v[84:87], v2 offset:23296
    v_mfma_f32_16x16x32_bf16 v[12:15], v[176:179], v[64:67], v[12:15]
    s_waitcnt lgkmcnt(2)
    v_mfma_f32_16x16x32_bf16 v[12:15], v[160:163], v[220:223], v[12:15]
    ds_read_b128 v[224:227], v2 offset:23424
    v_mfma_f32_16x16x32_bf16 v[16:19], v[176:179], v[220:223], v[16:19]
    v_mfma_f32_16x16x32_bf16 v[16:19], v[160:163], v[76:79], v[16:19]
    ds_read_b128 v[120:123], v2 offset:23552
    v_mfma_f32_16x16x32_bf16 v[12:15], v[164:167], v[76:79], v[12:15]
    s_waitcnt lgkmcnt(2)
    v_mfma_f32_16x16x32_bf16 v[12:15], v[156:159], v[68:71], v[12:15]
    ds_read_b128 v[148:151], v2 offset:23680
    v_mfma_f32_16x16x32_bf16 v[16:19], v[164:167], v[68:71], v[16:19]
    v_mfma_f32_16x16x32_bf16 v[16:19], v[156:159], v[84:87], v[16:19]
    ds_read_b128 v[236:239], v2 offset:23808
    v_mfma_f32_16x16x32_bf16 v[12:15], v[180:183], v[84:87], v[12:15]
    s_waitcnt lgkmcnt(2)
    v_mfma_f32_16x16x32_bf16 v[12:15], v[216:219], v[224:227], v[12:15]
    ds_read_b128 v[108:111], v2 offset:23936
    v_mfma_f32_16x16x32_bf16 v[16:19], v[180:183], v[224:227], v[16:19]
    v_mfma_f32_16x16x32_bf16 v[16:19], v[216:219], v[120:123], v[16:19]
    ds_read_b128 v[124:127], v2 offset:24064
    v_mfma_f32_16x16x32_bf16 v[12:15], v[244:247], v[120:123], v[12:15]
    s_waitcnt lgkmcnt(2)
    v_mfma_f32_16x16x32_bf16 v[12:15], v[52:55], v[148:151], v[12:15]
    ds_read_b128 v[136:139], v2 offset:24192
    v_mfma_f32_16x16x32_bf16 v[16:19], v[244:247], v[148:151], v[16:19]
    v_mfma_f32_16x16x32_bf16 v[16:19], v[52:55], v[236:239], v[16:19]
    ds_read_b128 v[240:243], v2 offset:25408
    v_mfma_f32_16x16x32_bf16 v[12:15], v[208:211], v[236:239], v[12:15]
    s_waitcnt lgkmcnt(2)
    v_mfma_f32_16x16x32_bf16 v[12:15], v[96:99], v[108:111], v[12:15]
    ds_read_b128 v[140:143], v2 offset:25536
    v_mfma_f32_16x16x32_bf16 v[16:19], v[208:211], v[108:111], v[16:19]
    v_mfma_f32_16x16x32_bf16 v[16:19], v[96:99], v[124:127], v[16:19]
    v_mfma_f32_16x16x32_bf16 v[12:15], v[132:135], v[124:127], v[12:15]
    s_waitcnt lgkmcnt(1)
    v_mfma_f32_16x16x32_bf16 v[12:15], v[112:115], v[136:139], v[12:15]
    v_mfma_f32_16x16x32_bf16 v[16:19], v[132:135], v[136:139], v[16:19]
    v_mfma_f32_16x16x32_bf16 v[16:19], v[112:115], v[240:243], v[16:19]
    v_mfma_f32_16x16x32_bf16 v[12:15], v[144:147], v[240:243], v[12:15]
    s_waitcnt lgkmcnt(0)
    s_waitcnt vmcnt(0)
    v_max3_u32 v152, v36, v37, v38
    v_mfma_f32_16x16x32_bf16 v[16:19], v[144:147], v[140:143], v[16:19]
    v_max_u32 v152, v152, v39
    v_cmp_eq_u32 vcc, -1, v152
    s_cbranch_vccnz L_again1
L_fin1:
    v_lshlrev_b32 v152, 16, v36
    v_and_b32 v153, s38, v36
    v_lshlrev_b32 v154, 16, v37
    v_and_b32 v155, s38, v37
    v_lshlrev_b32 v168, 16, v38
    v_and_b32 v169, s38, v38
    v_lshlrev_b32 v170, 16, v39
    v_and_b32 v171, s38, v39
    v_pk_add_f32 v[152:153], v[152:153], v[12:13]
    v_pk_add_f32 v[154:155], v[154:155], v[14:15]
    v_pk_mul_f32 v[152:153], v[152:153], s[36:37]
    v_pk_mul_f32 v[154:155], v[154:155], s[36:37]
    v_exp_f32 v152, v152
    v_exp_f32 v153, v153
    v_exp_f32 v154, v154
    v_exp_f32 v155, v155
    v_pk_add_f32 v[168:169], v[168:169], v[16:17]
    v_pk_add_f32 v[170:171], v[170:171], v[18:19]
    v_pk_mul_f32 v[168:169], v[168:169], s[36:37]
    v_pk_mul_f32 v[170:171], v[170:171], s[36:37]
    v_pk_add_f32 v[152:153], v[152:153], 1.0 op_sel_hi:[1,0]
    v_pk_add_f32 v[154:155], v[154:155], 1.0 op_sel_hi:[1,0]
    v_rcp_f32 v152, v152
    v_rcp_f32 v153, v153
    v_rcp_f32 v154, v154
    v_rcp_f32 v155, v155
    v_exp_f32 v168, v168
    v_exp_f32 v169, v169
    v_exp_f32 v170, v170
    v_exp_f32 v171, v171
    ds_write_b128 v33, v[152:155] offset:0
    v_pk_add_f32 v[168:169], v[168:169], 1.0 op_sel_hi:[1,0]
    v_pk_add_f32 v[170:171], v[170:171], 1.0 op_sel_hi:[1,0]
    v_rcp_f32 v168, v168
    v_rcp_f32 v169, v169
    v_rcp_f32 v170, v170
    v_rcp_f32 v171, v171
    s_nop 0
    ds_write_b128 v33, v[168:171] offset:4352
    s_waitcnt lgkmcnt(0)
    s_barrier
    ds_read_b128 v[252:255], v34
    ds_read_b128 v[172:175], v34 offset:8704
    s_waitcnt lgkmcnt(0)
    v_pk_mul_f32 v[252:253], v[252:253], v[172:173]
    v_pk_mul_f32 v[254:255], v[254:255], v[174:175]
    v_pk_fma_f32 v[252:253], v[252:253], -2.0, v[172:173] op_sel_hi:[1,0,1]
    v_pk_fma_f32 v[254:255], v[254:255], -2.0, v[174:175] op_sel_hi:[1,0,1]
    v_cvt_pk_bf16_f32 v252, v252, v253
    v_cvt_pk_bf16_f32 v253, v254, v255
    buffer_store_dwordx2 v[252:253], v35, s[24:27], 0 offen
    s_endpgm
L_again1:
    s_add_u32 s13, s13, 1
    s_cmp_ge_u32 s13, 200000
    s_cbranch_scc1 L_fin1
    buffer_load_dwordx4 v[36:39], v3, s[28:31], s44 offen sc1
    s_waitcnt vmcnt(0)
    v_max3_u32 v152, v36, v37, v38
    v_max_u32 v152, v152, v39
    v_cmp_eq_u32 vcc, -1, v152
    s_cbranch_vccnz L_again1
    s_branch L_fin1
.p2align 12
L_role2:
    s_load_dwordx2 s[28:29], s[0:1], 32
    s_load_dwordx2 s[24:25], s[0:1], 16
    s_cmp_eq_u32 s10, 1
    s_cbranch_scc1 L_pad2_0
    s_cmp_eq_u32 s10, 2
    s_cbranch_scc1 L_pad2_1
    s_cmp_eq_u32 s10, 3
    s_cbranch_scc1 L_pad2_2
L_main2:
    s_mov_b64 exec, -1
    s_setprio 1
    s_waitcnt vmcnt(0) lgkmcnt(0)
    s_barrier
    ds_read_b64_tr_b16 v[36:37], v1 offset:0
    ds_read_b64_tr_b16 v[38:39], v1 offset:512
    ds_read_b128 v[40:43], v2 offset:0
    ds_read_b128 v[44:47], v2 offset:128
    ds_read_b128 v[48:51], v2 offset:256
    ds_read_b128 v[52:55], v2 offset:384
    ds_read_b128 v[56:59], v2 offset:512
    ds_read_b128 v[60:63], v2 offset:640
    s_waitcnt lgkmcnt(5)
    v_mfma_f32_16x16x32_bf16 v[4:7], v[36:39], v[40:43], 0
    s_waitcnt lgkmcnt(4)
    ds_read_b128 v[64:67], v2 offset:768
    v_mfma_f32_16x16x32_bf16 v[8:11], v[36:39], v[44:47], 0
    s_waitcnt lgkmcnt(4)
    ds_read_b128 v[68:71], v2 offset:896
    v_mfma_f32_16x16x32_bf16 v[12:15], v[36:39], v[48:51], 0
    s_waitcnt lgkmcnt(4)
    v_mfma_f32_16x16x32_bf16 v[16:19], v[36:39], v[52:55], 0
    s_waitcnt lgkmcnt(3)
    s_barrier
    ds_read_b64_tr_b16 v[72:73], v1 offset:1024
    v_mfma_f32_16x16x32_bf16 v[20:23], v[36:39], v[56:59], 0
    s_waitcnt lgkmcnt(3)
    ds_read_b64_tr_b16 v[74:75], v1 offset:1536
    v_mfma_f32_16x16x32_bf16 v[24:27], v[36:39], v[60:63], 0
    s_waitcnt lgkmcnt(3)
    ds_read_b128 v[76:79], v2 offset:2112
    v_mfma_f32_16x16x32_bf16 v[28:31], v[36:39], v[64:67], 0
    s_waitcnt lgkmcnt(3)
    s_barrier
    v_mfma_f32_16x16x32_bf16 v[32:35], v[36:39], v[68:71], 0
    s_waitcnt lgkmcnt(1)
    ds_read_b64_tr_b16 v[80:81], v1 offset:2048
    v_mfma_f32_16x16x32_bf16 v[4:7], v[72:75], v[44:47], v[4:7]
    ds_read_b64_tr_b16 v[82:83], v1 offset:2560
    v_mfma_f32_16x16x32_bf16 v[8:11], v[72:75], v[48:51], v[8:11]
    v_mfma_f32_16x16x32_bf16 v[12:15], v[72:75], v[52:55], v[12:15]
    v_mfma_f32_16x16x32_bf16 v[16:19], v[72:75], v[56:59], v[16:19]
    v_mfma_f32_16x16x32_bf16 v[20:23], v[72:75], v[60:63], v[20:23]
    v_mfma_f32_16x16x32_bf16 v[24:27], v[72:75], v[64:67], v[24:27]
    s_lshr_b32 s9, s2, 2
    ds_read_b128 v[84:87], v2 offset:2240
    s_and_b32 s6, s9, 3
    v_mfma_f32_16x16x32_bf16 v[28:31], v[72:75], v[68:71], v[28:31]
    s_waitcnt lgkmcnt(1)
    s_barrier
    v_mfma_f32_16x16x32_bf16 v[32:35], v[72:75], v[76:79], v[32:35]
    s_lshr_b32 s7, s2, 5
    ds_read_b64_tr_b16 v[88:89], v1 offset:3072
    s_mov_b32 s26, 512000
    v_mfma_f32_16x16x32_bf16 v[4:7], v[80:83], v[48:51], v[4:7]
    s_mov_b32 s27, 0x20000
    ds_read_b64_tr_b16 v[90:91], v1 offset:3584
    s_bitcmp1_b32 s2, 4
    v_mfma_f32_16x16x32_bf16 v[8:11], v[80:83], v[52:55], v[8:11]
    s_cselect_b32 s8, s26, 0
    s_mov_b32 s30, 3162112
    s_mov_b32 s31, s27
    v_mfma_f32_16x16x32_bf16 v[12:15], v[80:83], v[56:59], v[12:15]
    s_lshl_b32 s12, s10, 10
    v_lshl_add_u32 v3, v0, 4, s12
    s_mul_i32 s12, s9, 49408
    v_mfma_f32_16x16x32_bf16 v[16:19], v[80:83], v[60:63], v[16:19]
    s_add_u32 s40, s12, 4096
    s_add_u32 s41, s12, 20480
    s_add_u32 s43, s12, 36864
    v_mfma_f32_16x16x32_bf16 v[20:23], v[80:83], v[64:67], v[20:23]
    s_add_u32 s44, s12, 28672
    ds_read_b128 v[92:95], v2 offset:2368
    s_mov_b32 s13, 0
    v_mfma_f32_16x16x32_bf16 v[24:27], v[80:83], v[68:71], v[24:27]
    s_barrier
    s_mov_b32 s38, 0xffff0000
    v_mfma_f32_16x16x32_bf16 v[28:31], v[80:83], v[76:79], v[28:31]
    s_waitcnt lgkmcnt(1)
    ds_read_b64_tr_b16 v[96:97], v1 offset:4096
    s_mov_b32 s36, 0x4038aa3b
    v_mfma_f32_16x16x32_bf16 v[32:35], v[80:83], v[84:87], v[32:35]
    s_mov_b32 s37, s36
    ds_read_b64_tr_b16 v[98:99], v1 offset:4608
    s_add_u32 s24, s24, s8
    v_mfma_f32_16x16x32_bf16 v[4:7], v[88:91], v[52:55], v[4:7]
    s_addc_u32 s25, s25, 0
    ds_read_b64_tr_b16 v[100:101], v1 offset:5120
    v_mfma_f32_16x16x32_bf16 v[8:11], v[88:91], v[56:59], v[8:11]
    ds_read_b64_tr_b16 v[102:103], v1 offset:5632
    v_mfma_f32_16x16x32_bf16 v[12:15], v[88:91], v[60:63], v[12:15]
    v_mfma_f32_16x16x32_bf16 v[16:19], v[88:91], v[64:67], v[16:19]
    v_mfma_f32_16x16x32_bf16 v[20:23], v[88:91], v[68:71], v[20:23]
    v_mfma_f32_16x16x32_bf16 v[24:27], v[88:91], v[76:79], v[24:27]
    v_mfma_f32_16x16x32_bf16 v[28:31], v[88:91], v[84:87], v[28:31]
    s_waitcnt lgkmcnt(0)
    v_mfma_f32_16x16x32_bf16 v[32:35], v[88:91], v[92:95], v[32:35]
    v_mfma_f32_16x16x32_bf16 v[4:7], v[96:99], v[56:59], v[4:7]
    v_mfma_f32_16x16x32_bf16 v[4:7], v[100:103], v[60:63], v[4:7]
    v_mfma_f32_16x16x32_bf16 v[8:11], v[96:99], v[60:63], v[8:11]
    v_mfma_f32_16x16x32_bf16 v[8:11], v[100:103], v[64:67], v[8:11]
    ds_read_b128 v[104:107], v2 offset:2496
    v_mfma_f32_16x16x32_bf16 v[12:15], v[96:99], v[64:67], v[12:15]
    ds_read_b128 v[108:111], v2 offset:2624
    v_mfma_f32_16x16x32_bf16 v[12:15], v[100:103], v[68:71], v[12:15]
    s_barrier
    v_mfma_f32_16x16x32_bf16 v[16:19], v[96:99], v[68:71], v[16:19]
    ds_read_b64_tr_b16 v[112:113], v1 offset:6144
    v_mfma_f32_16x16x32_bf16 v[16:19], v[100:103], v[76:79], v[16:19]
    ds_read_b64_tr_b16 v[114:115], v1 offset:6656
    v_mfma_f32_16x16x32_bf16 v[20:23], v[96:99], v[76:79], v[20:23]
    ds_read_b64_tr_b16 v[116:117], v1 offset:7168
    v_mfma_f32_16x16x32_bf16 v[20:23], v[100:103], v[84:87], v[20:23]
    ds_read_b64_tr_b16 v[118:119], v1 offset:7680
    v_mfma_f32_16x16x32_bf16 v[24:27], v[96:99], v[84:87], v[24:27]
    v_mfma_f32_16x16x32_bf16 v[24:27], v[100:103], v[92:95], v[24:27]
    v_mfma_f32_16x16x32_bf16 v[28:31], v[96:99], v[92:95], v[28:31]
    s_waitcnt lgkmcnt(2)
    v_mfma_f32_16x16x32_bf16 v[28:31], v[100:103], v[104:107], v[28:31]
    v_mfma_f32_16x16x32_bf16 v[32:35], v[96:99], v[104:107], v[32:35]
    v_mfma_f32_16x16x32_bf16 v[32:35], v[100:103], v[108:111], v[32:35]
    v_mfma_f32_16x16x32_bf16 v[4:7], v[112:115], v[64:67], v[4:7]
    s_waitcnt lgkmcnt(0)
    v_mfma_f32_16x16x32_bf16 v[4:7], v[116:119], v[68:71], v[4:7]
    v_mfma_f32_16x16x32_bf16 v[8:11], v[112:115], v[68:71], v[8:11]
    v_mfma_f32_16x16x32_bf16 v[8:11], v[116:119], v[76:79], v[8:11]
    ds_read_b128 v[120:123], v2 offset:2752
    v_mfma_f32_16x16x32_bf16 v[12:15], v[112:115], v[76:79], v[12:15]
    ds_read_b128 v[124:127], v2 offset:2880
    v_mfma_f32_16x16x32_bf16 v[12:15], v[116:119], v[84:87], v[12:15]
    s_barrier
    v_mfma_f32_16x16x32_bf16 v[16:19], v[112:115], v[84:87], v[16:19]
    ds_read_b64_tr_b16 v[128:129], v1 offset:8192
    v_mfma_f32_16x16x32_bf16 v[16:19], v[116:119], v[92:95], v[16:19]
    ds_read_b64_tr_b16 v[130:131], v1 offset:8704
    v_mfma_f32_16x16x32_bf16 v[20:23], v[112:115], v[92:95], v[20:23]
    ds_read_b64_tr_b16 v[132:133], v1 offset:9216
    v_mfma_f32_16x16x32_bf16 v[20:23], v[116:119], v[104:107], v[20:23]
    ds_read_b64_tr_b16 v[134:135], v1 offset:9728
    v_mfma_f32_16x16x32_bf16 v[24:27], v[112:115], v[104:107], v[24:27]
    v_mfma_f32_16x16x32_bf16 v[24:27], v[116:119], v[108:111], v[24:27]
L_pad2_0:
    s_cbranch_execz L_pad2_3
    v_mfma_f32_16x16x32_bf16 v[28:31], v[112:115], v[108:111], v[28:31]
    s_waitcnt lgkmcnt(2)
    v_mfma_f32_16x16x32_bf16 v[28:31], v[116:119], v[120:123], v[28:31]
    v_mfma_f32_16x16x32_bf16 v[32:35], v[112:115], v[120:123], v[32:35]
    v_mfma_f32_16x16x32_bf16 v[32:35], v[116:119], v[124:127], v[32:35]
    v_mfma_f32_16x16x32_bf16 v[4:7], v[128:131], v[76:79], v[4:7]
    s_waitcnt lgkmcnt(0)
    v_mfma_f32_16x16x32_bf16 v[4:7], v[132:135], v[84:87], v[4:7]
    v_mfma_f32_16x16x32_bf16 v[8:11], v[128:131], v[84:87], v[8:11]
    v_mfma_f32_16x16x32_bf16 v[8:11], v[132:135], v[92:95], v[8:11]
    ds_read_b128 v[136:139], v2 offset:3008
    v_mfma_f32_16x16x32_bf16 v[12:15], v[128:131], v[92:95], v[12:15]
    ds_read_b128 v[140:143], v2 offset:4224
    v_mfma_f32_16x16x32_bf16 v[12:15], v[132:135], v[104:107], v[12:15]
    s_barrier
    v_mfma_f32_16x16x32_bf16 v[16:19], v[128:131], v[104:107], v[16:19]
    ds_read_b64_tr_b16 v[144:145], v1 offset:10240
    v_mfma_f32_16x16x32_bf16 v[16:19], v[132:135], v[108:111], v[16:19]
    ds_read_b64_tr_b16 v[146:147], v1 offset:10752
    v_mfma_f32_16x16x32_bf16 v[20:23], v[128:131], v[108:111], v[20:23]
    ds_read_b64_tr_b16 v[148:149], v1 offset:11264
    v_mfma_f32_16x16x32_bf16 v[20:23], v[132:135], v[120:123], v[20:23]
    ds_read_b64_tr_b16 v[150:151], v1 offset:11776
    v_mfma_f32_16x16x32_bf16 v[24:27], v[128:131], v[120:123], v[24:27]
    v_mfma_f32_16x16x32_bf16 v[24:27], v[132:135], v[124:127], v[24:27]
    v_mfma_f32_16x16x32_bf16 v[28:31], v[128:131], v[124:127], v[28:31]
    s_waitcnt lgkmcnt(2)
    v_mfma_f32_16x16x32_bf16 v[28:31], v[132:135], v[136:139], v[28:31]
    v_mfma_f32_16x16x32_bf16 v[32:35], v[128:131], v[136:139], v[32:35]
    v_mfma_f32_16x16x32_bf16 v[32:35], v[132:135], v[140:143], v[32:35]
    v_mfma_f32_16x16x32_bf16 v[4:7], v[144:147], v[92:95], v[4:7]
    s_waitcnt lgkmcnt(0)
    v_mfma_f32_16x16x32_bf16 v[4:7], v[148:151], v[104:107], v[4:7]
    v_mfma_f32_16x16x32_bf16 v[8:11], v[144:147], v[104:107], v[8:11]
    v_mfma_f32_16x16x32_bf16 v[8:11], v[148:151], v[108:111], v[8:11]
    ds_read_b128 v[152:155], v2 offset:4352
    v_mfma_f32_16x16x32_bf16 v[12:15], v[144:147], v[108:111], v[12:15]
    ds_read_b128 v[156:159], v2 offset:4480
    v_mfma_f32_16x16x32_bf16 v[12:15], v[148:151], v[120:123], v[12:15]
    s_barrier
    v_mfma_f32_16x16x32_bf16 v[16:19], v[144:147], v[120:123], v[16:19]
    ds_read_b64_tr_b16 v[160:161], v1 offset:12288
    v_mfma_f32_16x16x32_bf16 v[16:19], v[148:151], v[124:127], v[16:19]
    ds_read_b64_tr_b16 v[162:163], v1 offset:12800
    v_mfma_f32_16x16x32_bf16 v[20:23], v[144:147], v[124:127], v[20:23]
    ds_read_b64_tr_b16 v[164:165], v1 offset:13312
    v_mfma_f32_16x16x32_bf16 v[20:23], v[148:151], v[136:139], v[20:23]
    ds_read_b64_tr_b16 v[166:167], v1 offset:13824
    v_mfma_f32_16x16x32_bf16 v[24:27], v[144:147], v[136:139], v[24:27]
    v_mfma_f32_16x16x32_bf16 v[24:27], v[148:151], v[140:143], v[24:27]
    v_mfma_f32_16x16x32_bf16 v[28:31], v[144:147], v[140:143], v[28:31]
    s_waitcnt lgkmcnt(2)
    v_mfma_f32_16x16x32_bf16 v[28:31], v[148:151], v[152:155], v[28:31]
    v_mfma_f32_16x16x32_bf16 v[32:35], v[144:147], v[152:155], v[32:35]
    v_mfma_f32_16x16x32_bf16 v[32:35], v[148:151], v[156:159], v[32:35]
    v_mfma_f32_16x16x32_bf16 v[4:7], v[160:163], v[108:111], v[4:7]
    s_waitcnt lgkmcnt(0)
    v_mfma_f32_16x16x32_bf16 v[4:7], v[164:167], v[120:123], v[4:7]
    v_mfma_f32_16x16x32_bf16 v[8:11], v[160:163], v[120:123], v[8:11]
    ds_read_b128 v[168:171], v2 offset:4608
    v_mfma_f32_16x16x32_bf16 v[8:11], v[164:167], v[124:127], v[8:11]
    ds_read_b128 v[172:175], v2 offset:4736
    v_mfma_f32_16x16x32_bf16 v[12:15], v[160:163], v[124:127], v[12:15]
    ds_read_b128 v[176:179], v2 offset:64
    v_mfma_f32_16x16x32_bf16 v[12:15], v[164:167], v[136:139], v[12:15]
    s_barrier
    v_mfma_f32_16x16x32_bf16 v[16:19], v[160:163], v[136:139], v[16:19]
    ds_read_b64_tr_b16 v[180:181], v1 offset:14336
    v_mfma_f32_16x16x32_bf16 v[16:19], v[164:167], v[140:143], v[16:19]
    ds_read_b64_tr_b16 v[182:183], v1 offset:14848
    v_mfma_f32_16x16x32_bf16 v[20:23], v[160:163], v[140:143], v[20:23]
    ds_read_b64_tr_b16 v[184:185], v1 offset:15360
    v_mfma_f32_16x16x32_bf16 v[20:23], v[164:167], v[152:155], v[20:23]
    ds_read_b64_tr_b16 v[186:187], v1 offset:15872
    v_mfma_f32_16x16x32_bf16 v[24:27], v[160:163], v[152:155], v[24:27]
    v_mfma_f32_16x16x32_bf16 v[24:27], v[164:167], v[156:159], v[24:27]
    ds_read_b128 v[188:191], v2 offset:192
    v_mfma_f32_16x16x32_bf16 v[28:31], v[160:163], v[156:159], v[28:31]
    s_waitcnt lgkmcnt(3)
    ds_read_b128 v[192:195], v2 offset:320
    v_mfma_f32_16x16x32_bf16 v[28:31], v[164:167], v[168:171], v[28:31]
    v_mfma_f32_16x16x32_bf16 v[32:35], v[160:163], v[168:171], v[32:35]
    ds_read_b128 v[196:199], v2 offset:448
    v_mfma_f32_16x16x32_bf16 v[32:35], v[164:167], v[172:175], v[32:35]
    ds_read_b128 v[200:203], v2 offset:576
    v_mfma_f32_16x16x32_bf16 v[4:7], v[180:183], v[124:127], v[4:7]
    s_waitcnt lgkmcnt(3)
    ds_read_b128 v[204:207], v2 offset:704
    v_mfma_f32_16x16x32_bf16 v[4:7], v[184:187], v[176:179], v[4:7]
    v_mfma_f32_16x16x32_bf16 v[8:11], v[180:183], v[136:139], v[8:11]
    ds_read_b128 v[208:211], v2 offset:832
    v_mfma_f32_16x16x32_bf16 v[8:11], v[184:187], v[188:191], v[8:11]
    ds_read_b128 v[212:215], v2 offset:4864
    v_mfma_f32_16x16x32_bf16 v[12:15], v[180:183], v[140:143], v[12:15]
    s_waitcnt lgkmcnt(3)
    ds_read_b128 v[216:219], v2 offset:960
    v_mfma_f32_16x16x32_bf16 v[12:15], v[184:187], v[192:195], v[12:15]
    s_barrier
    v_mfma_f32_16x16x32_bf16 v[16:19], v[180:183], v[152:155], v[16:19]
    ds_read_b64_tr_b16 v[220:221], v1 offset:16384
    v_mfma_f32_16x16x32_bf16 v[16:19], v[184:187], v[196:199], v[16:19]
    ds_read_b64_tr_b16 v[222:223], v1 offset:16896
    v_mfma_f32_16x16x32_bf16 v[20:23], v[180:183], v[156:159], v[20:23]
    ds_read_b64_tr_b16 v[224:225], v1 offset:17408
    v_mfma_f32_16x16x32_bf16 v[20:23], v[184:187], v[200:203], v[20:23]
    ds_read_b64_tr_b16 v[226:227], v1 offset:17920
    v_mfma_f32_16x16x32_bf16 v[24:27], v[180:183], v[168:171], v[24:27]
    s_waitcnt lgkmcnt(4)
    v_mfma_f32_16x16x32_bf16 v[24:27], v[184:187], v[204:207], v[24:27]
    v_mfma_f32_16x16x32_bf16 v[28:31], v[180:183], v[172:175], v[28:31]
    v_mfma_f32_16x16x32_bf16 v[28:31], v[184:187], v[208:211], v[28:31]
    v_mfma_f32_16x16x32_bf16 v[32:35], v[180:183], v[212:215], v[32:35]
    v_mfma_f32_16x16x32_bf16 v[32:35], v[184:187], v[216:219], v[32:35]
    s_waitcnt lgkmcnt(0)
    ds_read_b128 v[228:231], v2 offset:2176
    v_mfma_f32_16x16x32_bf16 v[4:7], v[220:223], v[188:191], v[4:7]
    ds_read_b128 v[232:235], v2 offset:2304
    v_mfma_f32_16x16x32_bf16 v[4:7], v[224:227], v[192:195], v[4:7]
    s_barrier
    v_mfma_f32_16x16x32_bf16 v[8:11], v[220:223], v[192:195], v[8:11]
    ds_read_b64_tr_b16 v[236:237], v1 offset:18432
    v_mfma_f32_16x16x32_bf16 v[8:11], v[224:227], v[196:199], v[8:11]
    ds_read_b64_tr_b16 v[238:239], v1 offset:18944
    v_mfma_f32_16x16x32_bf16 v[12:15], v[220:223], v[196:199], v[12:15]
    ds_read_b64_tr_b16 v[240:241], v1 offset:19456
    v_mfma_f32_16x16x32_bf16 v[12:15], v[224:227], v[200:203], v[12:15]
    ds_read_b64_tr_b16 v[242:243], v1 offset:19968
    v_mfma_f32_16x16x32_bf16 v[16:19], v[220:223], v[200:203], v[16:19]
    v_mfma_f32_16x16x32_bf16 v[16:19], v[224:227], v[204:207], v[16:19]
    v_mfma_f32_16x16x32_bf16 v[28:31], v[220:223], v[216:219], v[28:31]
    s_waitcnt lgkmcnt(2)
    v_mfma_f32_16x16x32_bf16 v[28:31], v[224:227], v[228:231], v[28:31]
    v_mfma_f32_16x16x32_bf16 v[32:35], v[220:223], v[228:231], v[32:35]
    v_mfma_f32_16x16x32_bf16 v[32:35], v[224:227], v[232:235], v[32:35]
    ds_read_b128 v[244:247], v2 offset:2432
    v_mfma_f32_16x16x32_bf16 v[4:7], v[236:239], v[196:199], v[4:7]
    s_waitcnt lgkmcnt(1)
    ds_read_b128 v[248:251], v2 offset:2560
    v_mfma_f32_16x16x32_bf16 v[4:7], v[240:243], v[200:203], v[4:7]
    s_barrier
    v_mfma_f32_16x16x32_bf16 v[8:11], v[236:239], v[200:203], v[8:11]
    ds_read_b64_tr_b16 v[252:253], v1 offset:20480
    v_mfma_f32_16x16x32_bf16 v[8:11], v[240:243], v[204:207], v[8:11]
L_pad2_1:
    s_cbranch_execz L_pad2_4
    ds_read_b64_tr_b16 v[254:255], v1 offset:20992
    v_mfma_f32_16x16x32_bf16 v[12:15], v[236:239], v[204:207], v[12:15]
    ds_read_b64_tr_b16 v[40:41], v1 offset:21504
    v_mfma_f32_16x16x32_bf16 v[12:15], v[240:243], v[208:211], v[12:15]
    ds_read_b64_tr_b16 v[42:43], v1 offset:22016
    v_mfma_f32_16x16x32_bf16 v[16:19], v[236:239], v[208:211], v[16:19]
    v_mfma_f32_16x16x32_bf16 v[16:19], v[240:243], v[216:219], v[16:19]
    v_mfma_f32_16x16x32_bf16 v[28:31], v[236:239], v[232:235], v[28:31]
    s_waitcnt lgkmcnt(2)
    v_mfma_f32_16x16x32_bf16 v[28:31], v[240:243], v[244:247], v[28:31]
    v_mfma_f32_16x16x32_bf16 v[32:35], v[236:239], v[244:247], v[32:35]
    v_mfma_f32_16x16x32_bf16 v[32:35], v[240:243], v[248:251], v[32:35]
    ds_read_b128 v[36:39], v2 offset:2688
    v_mfma_f32_16x16x32_bf16 v[4:7], v[252:255], v[204:207], v[4:7]
    s_waitcnt lgkmcnt(1)
    ds_read_b128 v[44:47], v2 offset:2816
    v_mfma_f32_16x16x32_bf16 v[4:7], v[40:43], v[208:211], v[4:7]
    s_barrier
    v_mfma_f32_16x16x32_bf16 v[8:11], v[252:255], v[208:211], v[8:11]
    ds_read_b64_tr_b16 v[72:73], v1 offset:22528
    v_mfma_f32_16x16x32_bf16 v[8:11], v[40:43], v[216:219], v[8:11]
    ds_read_b64_tr_b16 v[74:75], v1 offset:23040
    v_mfma_f32_16x16x32_bf16 v[12:15], v[252:255], v[216:219], v[12:15]
    ds_read_b64_tr_b16 v[48:49], v1 offset:23552
    v_mfma_f32_16x16x32_bf16 v[12:15], v[40:43], v[228:231], v[12:15]
    ds_read_b64_tr_b16 v[50:51], v1 offset:24064
    v_mfma_f32_16x16x32_bf16 v[16:19], v[252:255], v[228:231], v[16:19]
    v_mfma_f32_16x16x32_bf16 v[16:19], v[40:43], v[232:235], v[16:19]
    v_mfma_f32_16x16x32_bf16 v[28:31], v[252:255], v[248:251], v[28:31]
    s_waitcnt lgkmcnt(2)
    v_mfma_f32_16x16x32_bf16 v[28:31], v[40:43], v[36:39], v[28:31]
    v_mfma_f32_16x16x32_bf16 v[32:35], v[252:255], v[36:39], v[32:35]
    v_mfma_f32_16x16x32_bf16 v[32:35], v[40:43], v[44:47], v[32:35]
    ds_read_b128 v[80:83], v2 offset:2944
    v_mfma_f32_16x16x32_bf16 v[4:7], v[72:75], v[216:219], v[4:7]
    s_waitcnt lgkmcnt(1)
    ds_read_b128 v[52:55], v2 offset:3072
    v_mfma_f32_16x16x32_bf16 v[4:7], v[48:51], v[228:231], v[4:7]
    s_barrier
    v_mfma_f32_16x16x32_bf16 v[8:11], v[72:75], v[228:231], v[8:11]
    ds_read_b64_tr_b16 v[88:89], v1 offset:0
    v_mfma_f32_16x16x32_bf16 v[8:11], v[48:51], v[232:235], v[8:11]
    ds_read_b64_tr_b16 v[90:91], v1 offset:512
    v_mfma_f32_16x16x32_bf16 v[12:15], v[72:75], v[232:235], v[12:15]
    ds_read_b64_tr_b16 v[56:57], v1 offset:1024
    v_mfma_f32_16x16x32_bf16 v[12:15], v[48:51], v[244:247], v[12:15]
    ds_read_b64_tr_b16 v[58:59], v1 offset:1536
    v_mfma_f32_16x16x32_bf16 v[16:19], v[72:75], v[244:247], v[16:19]
    v_mfma_f32_16x16x32_bf16 v[16:19], v[48:51], v[248:251], v[16:19]
    v_mfma_f32_16x16x32_bf16 v[28:31], v[72:75], v[44:47], v[28:31]
    s_waitcnt lgkmcnt(2)
    v_mfma_f32_16x16x32_bf16 v[28:31], v[48:51], v[80:83], v[28:31]
    v_mfma_f32_16x16x32_bf16 v[32:35], v[72:75], v[80:83], v[32:35]
    v_mfma_f32_16x16x32_bf16 v[32:35], v[48:51], v[52:55], v[32:35]
    ds_read_b128 v[60:63], v2 offset:4288
    v_mfma_f32_16x16x32_bf16 v[4:7], v[88:91], v[232:235], v[4:7]
    s_waitcnt lgkmcnt(1)
    ds_read_b128 v[96:99], v2 offset:4416
    v_mfma_f32_16x16x32_bf16 v[4:7], v[56:59], v[244:247], v[4:7]
    s_barrier
    v_mfma_f32_16x16x32_bf16 v[8:11], v[88:91], v[244:247], v[8:11]
    ds_read_b64_tr_b16 v[100:101], v1 offset:2048
    v_mfma_f32_16x16x32_bf16 v[8:11], v[56:59], v[248:251], v[8:11]
    ds_read_b64_tr_b16 v[102:103], v1 offset:2560
    v_mfma_f32_16x16x32_bf16 v[12:15], v[88:91], v[248:251], v[12:15]
    ds_read_b64_tr_b16 v[64:65], v1 offset:3072
    v_mfma_f32_16x16x32_bf16 v[12:15], v[56:59], v[36:39], v[12:15]
    ds_read_b64_tr_b16 v[66:67], v1 offset:3584
    v_mfma_f32_16x16x32_bf16 v[16:19], v[88:91], v[36:39], v[16:19]
    v_mfma_f32_16x16x32_bf16 v[16:19], v[56:59], v[44:47], v[16:19]
    v_mfma_f32_16x16x32_bf16 v[28:31], v[88:91], v[52:55], v[28:31]
    s_waitcnt lgkmcnt(2)
    v_mfma_f32_16x16x32_bf16 v[28:31], v[56:59], v[60:63], v[28:31]
    v_mfma_f32_16x16x32_bf16 v[32:35], v[88:91], v[60:63], v[32:35]
    v_mfma_f32_16x16x32_bf16 v[32:35], v[56:59], v[96:99], v[32:35]
    ds_read_b128 v[68:71], v2 offset:4544
    v_mfma_f32_16x16x32_bf16 v[4:7], v[100:103], v[248:251], v[4:7]
    s_waitcnt lgkmcnt(1)
    ds_read_b128 v[112:115], v2 offset:4672
    v_mfma_f32_16x16x32_bf16 v[4:7], v[64:67], v[36:39], v[4:7]
    s_barrier
    v_mfma_f32_16x16x32_bf16 v[8:11], v[100:103], v[36:39], v[8:11]
    ds_read_b64_tr_b16 v[116:117], v1 offset:4096
    v_mfma_f32_16x16x32_bf16 v[8:11], v[64:67], v[44:47], v[8:11]
    ds_read_b64_tr_b16 v[118:119], v1 offset:4608
    v_mfma_f32_16x16x32_bf16 v[12:15], v[100:103], v[44:47], v[12:15]
    ds_read_b64_tr_b16 v[76:77], v1 offset:5120
    v_mfma_f32_16x16x32_bf16 v[12:15], v[64:67], v[80:83], v[12:15]
    ds_read_b64_tr_b16 v[78:79], v1 offset:5632
    v_mfma_f32_16x16x32_bf16 v[16:19], v[100:103], v[80:83], v[16:19]
    v_mfma_f32_16x16x32_bf16 v[16:19], v[64:67], v[52:55], v[16:19]
    ds_read_b128 v[84:87], v2 offset:4800
    v_mfma_f32_16x16x32_bf16 v[28:31], v[100:103], v[96:99], v[28:31]
    s_waitcnt lgkmcnt(3)
    ds_read_b128 v[128:131], v2 offset:4928
    v_mfma_f32_16x16x32_bf16 v[28:31], v[64:67], v[68:71], v[28:31]
    v_mfma_f32_16x16x32_bf16 v[32:35], v[100:103], v[68:71], v[32:35]
    ds_read_b128 v[132:135], v2 offset:21120
    v_mfma_f32_16x16x32_bf16 v[32:35], v[64:67], v[112:115], v[32:35]
    ds_read_b128 v[92:95], v2 offset:21248
    v_mfma_f32_16x16x32_bf16 v[4:7], v[116:119], v[44:47], v[4:7]
    s_waitcnt lgkmcnt(3)
    ds_read_b128 v[104:107], v2 offset:21376
    v_mfma_f32_16x16x32_bf16 v[4:7], v[76:79], v[80:83], v[4:7]
    s_barrier
    v_mfma_f32_16x16x32_bf16 v[8:11], v[116:119], v[80:83], v[8:11]
    ds_read_b64_tr_b16 v[144:145], v1 offset:6144
    v_mfma_f32_16x16x32_bf16 v[8:11], v[76:79], v[52:55], v[8:11]
    ds_read_b64_tr_b16 v[146:147], v1 offset:6656
    v_mfma_f32_16x16x32_bf16 v[12:15], v[116:119], v[52:55], v[12:15]
    ds_read_b64_tr_b16 v[148:149], v1 offset:7168
    v_mfma_f32_16x16x32_bf16 v[12:15], v[76:79], v[60:63], v[12:15]
    ds_read_b64_tr_b16 v[150:151], v1 offset:7680
    v_mfma_f32_16x16x32_bf16 v[16:19], v[116:119], v[60:63], v[16:19]
    v_mfma_f32_16x16x32_bf16 v[16:19], v[76:79], v[96:99], v[16:19]
    ds_read_b128 v[108:111], v2 offset:21504
    v_mfma_f32_16x16x32_bf16 v[28:31], v[116:119], v[112:115], v[28:31]
    ds_read_b128 v[120:123], v2 offset:21632
    v_mfma_f32_16x16x32_bf16 v[28:31], v[76:79], v[84:87], v[28:31]
    v_mfma_f32_16x16x32_bf16 v[32:35], v[116:119], v[84:87], v[32:35]
    s_waitcnt lgkmcnt(2)
    ds_read_b128 v[160:163], v2 offset:21888
    v_mfma_f32_16x16x32_bf16 v[32:35], v[76:79], v[128:131], v[32:35]
    ds_read_b128 v[164:167], v2 offset:22016
    v_mfma_f32_16x16x32_bf16 v[4:7], v[144:147], v[132:135], v[4:7]
    ds_read_b128 v[124:127], v2 offset:23232
    v_mfma_f32_16x16x32_bf16 v[4:7], v[148:151], v[92:95], v[4:7]
    s_barrier
    v_mfma_f32_16x16x32_bf16 v[8:11], v[144:147], v[92:95], v[8:11]
    ds_read_b64_tr_b16 v[176:177], v1 offset:8192
    v_mfma_f32_16x16x32_bf16 v[8:11], v[148:151], v[104:107], v[8:11]
    ds_read_b64_tr_b16 v[178:179], v1 offset:8704
    v_mfma_f32_16x16x32_bf16 v[12:15], v[144:147], v[104:107], v[12:15]
    s_waitcnt lgkmcnt(3)
    ds_read_b64_tr_b16 v[136:137], v1 offset:9216
    v_mfma_f32_16x16x32_bf16 v[12:15], v[148:151], v[108:111], v[12:15]
    ds_read_b64_tr_b16 v[138:139], v1 offset:9728
L_pad2_2:
    s_cbranch_execz L_pad2_5
    v_mfma_f32_16x16x32_bf16 v[16:19], v[144:147], v[108:111], v[16:19]
    v_mfma_f32_16x16x32_bf16 v[16:19], v[148:151], v[120:123], v[16:19]
    v_mfma_f32_16x16x32_bf16 v[28:31], v[144:147], v[160:163], v[28:31]
    v_mfma_f32_16x16x32_bf16 v[28:31], v[148:151], v[164:167], v[28:31]
    ds_read_b128 v[140:143], v2 offset:21760
    v_mfma_f32_16x16x32_bf16 v[32:35], v[144:147], v[164:167], v[32:35]
    s_waitcnt lgkmcnt(1)
    v_mfma_f32_16x16x32_bf16 v[32:35], v[148:151], v[124:127], v[32:35]
    ds_read_b128 v[152:155], v2 offset:23360
    v_mfma_f32_16x16x32_bf16 v[4:7], v[176:179], v[104:107], v[4:7]
    ds_read_b128 v[156:159], v2 offset:23488
    v_mfma_f32_16x16x32_bf16 v[4:7], v[136:139], v[108:111], v[4:7]
    s_barrier
    v_mfma_f32_16x16x32_bf16 v[8:11], v[176:179], v[108:111], v[8:11]
    ds_read_b64_tr_b16 v[168:169], v1 offset:10240
    v_mfma_f32_16x16x32_bf16 v[8:11], v[136:139], v[120:123], v[8:11]
    ds_read_b64_tr_b16 v[170:171], v1 offset:10752
    v_mfma_f32_16x16x32_bf16 v[12:15], v[176:179], v[120:123], v[12:15]
    s_waitcnt lgkmcnt(3)
    ds_read_b64_tr_b16 v[172:173], v1 offset:11264
    v_mfma_f32_16x16x32_bf16 v[12:15], v[136:139], v[140:143], v[12:15]
    ds_read_b64_tr_b16 v[174:175], v1 offset:11776
    v_mfma_f32_16x16x32_bf16 v[16:19], v[176:179], v[140:143], v[16:19]
    v_mfma_f32_16x16x32_bf16 v[16:19], v[136:139], v[160:163], v[16:19]
    v_mfma_f32_16x16x32_bf16 v[28:31], v[176:179], v[124:127], v[28:31]
    v_mfma_f32_16x16x32_bf16 v[28:31], v[136:139], v[152:155], v[28:31]
    v_mfma_f32_16x16x32_bf16 v[32:35], v[176:179], v[152:155], v[32:35]
    s_waitcnt lgkmcnt(0)
    v_mfma_f32_16x16x32_bf16 v[32:35], v[136:139], v[156:159], v[32:35]
    ds_read_b128 v[180:183], v2 offset:23616
    v_mfma_f32_16x16x32_bf16 v[4:7], v[168:171], v[120:123], v[4:7]
    ds_read_b128 v[212:215], v2 offset:23744
    v_mfma_f32_16x16x32_bf16 v[4:7], v[172:175], v[140:143], v[4:7]
    s_barrier
    v_mfma_f32_16x16x32_bf16 v[8:11], v[168:171], v[140:143], v[8:11]
    ds_read_b64_tr_b16 v[184:185], v1 offset:12288
    v_mfma_f32_16x16x32_bf16 v[8:11], v[172:175], v[160:163], v[8:11]
    ds_read_b64_tr_b16 v[186:187], v1 offset:12800
    v_mfma_f32_16x16x32_bf16 v[12:15], v[168:171], v[160:163], v[12:15]
    ds_read_b64_tr_b16 v[188:189], v1 offset:13312
    v_mfma_f32_16x16x32_bf16 v[12:15], v[172:175], v[164:167], v[12:15]
    ds_read_b64_tr_b16 v[190:191], v1 offset:13824
    v_mfma_f32_16x16x32_bf16 v[16:19], v[168:171], v[164:167], v[16:19]
    v_mfma_f32_16x16x32_bf16 v[16:19], v[172:175], v[124:127], v[16:19]
    v_mfma_f32_16x16x32_bf16 v[28:31], v[168:171], v[156:159], v[28:31]
    s_waitcnt lgkmcnt(2)
    v_mfma_f32_16x16x32_bf16 v[28:31], v[172:175], v[180:183], v[28:31]
    v_mfma_f32_16x16x32_bf16 v[32:35], v[168:171], v[180:183], v[32:35]
    v_mfma_f32_16x16x32_bf16 v[32:35], v[172:175], v[212:215], v[32:35]
    ds_read_b128 v[192:195], v2 offset:23872
    v_mfma_f32_16x16x32_bf16 v[4:7], v[184:187], v[160:163], v[4:7]
    s_waitcnt lgkmcnt(1)
    ds_read_b128 v[196:199], v2 offset:24000
    v_mfma_f32_16x16x32_bf16 v[4:7], v[188:191], v[164:167], v[4:7]
    s_barrier
    v_mfma_f32_16x16x32_bf16 v[8:11], v[184:187], v[164:167], v[8:11]
    ds_read_b64_tr_b16 v[200:201], v1 offset:14336
    v_mfma_f32_16x16x32_bf16 v[8:11], v[188:191], v[124:127], v[8:11]
    ds_read_b64_tr_b16 v[202:203], v1 offset:14848
    v_mfma_f32_16x16x32_bf16 v[12:15], v[184:187], v[124:127], v[12:15]
    ds_read_b64_tr_b16 v[204:205], v1 offset:15360
    v_mfma_f32_16x16x32_bf16 v[12:15], v[188:191], v[152:155], v[12:15]
    ds_read_b64_tr_b16 v[206:207], v1 offset:15872
    v_mfma_f32_16x16x32_bf16 v[16:19], v[184:187], v[152:155], v[16:19]
    v_mfma_f32_16x16x32_bf16 v[16:19], v[188:191], v[156:159], v[16:19]
    v_mfma_f32_16x16x32_bf16 v[28:31], v[184:187], v[212:215], v[28:31]
    s_waitcnt lgkmcnt(2)
    v_mfma_f32_16x16x32_bf16 v[28:31], v[188:191], v[192:195], v[28:31]
    v_mfma_f32_16x16x32_bf16 v[32:35], v[184:187], v[192:195], v[32:35]
    v_mfma_f32_16x16x32_bf16 v[32:35], v[188:191], v[196:199], v[32:35]
    ds_read_b128 v[208:211], v2 offset:24128
    v_mfma_f32_16x16x32_bf16 v[4:7], v[200:203], v[124:127], v[4:7]
    s_waitcnt lgkmcnt(1)
    ds_read_b128 v[216:219], v2 offset:25344
    v_mfma_f32_16x16x32_bf16 v[4:7], v[204:207], v[152:155], v[4:7]
    s_barrier
    v_mfma_f32_16x16x32_bf16 v[8:11], v[200:203], v[152:155], v[8:11]
    ds_read_b64_tr_b16 v[228:229], v1 offset:16384
    v_mfma_f32_16x16x32_bf16 v[8:11], v[204:207], v[156:159], v[8:11]
    ds_read_b64_tr_b16 v[230:231], v1 offset:16896
    v_mfma_f32_16x16x32_bf16 v[12:15], v[200:203], v[156:159], v[12:15]
    ds_read_b64_tr_b16 v[232:233], v1 offset:17408
    v_mfma_f32_16x16x32_bf16 v[12:15], v[204:207], v[180:183], v[12:15]
    ds_read_b64_tr_b16 v[234:235], v1 offset:17920
    v_mfma_f32_16x16x32_bf16 v[16:19], v[200:203], v[180:183], v[16:19]
    v_mfma_f32_16x16x32_bf16 v[16:19], v[204:207], v[212:215], v[16:19]
    v_mfma_f32_16x16x32_bf16 v[28:31], v[200:203], v[196:199], v[28:31]
    s_waitcnt lgkmcnt(2)
    ds_read_b128 v[244:247], v2 offset:25472
    v_mfma_f32_16x16x32_bf16 v[28:31], v[204:207], v[208:211], v[28:31]
    v_mfma_f32_16x16x32_bf16 v[32:35], v[200:203], v[208:211], v[32:35]
    ds_read_b128 v[248:251], v2 offset:25600
    v_mfma_f32_16x16x32_bf16 v[32:35], v[204:207], v[216:219], v[32:35]
    ds_read_b128 v[36:39], v2 offset:25728
    v_mfma_f32_16x16x32_bf16 v[4:7], v[228:231], v[156:159], v[4:7]
    s_waitcnt lgkmcnt(3)
    ds_read_b128 v[68:71], v2 offset:25856
    v_mfma_f32_16x16x32_bf16 v[4:7], v[232:235], v[180:183], v[4:7]
    s_barrier
    v_mfma_f32_16x16x32_bf16 v[8:11], v[228:231], v[180:183], v[8:11]
    ds_read_b64_tr_b16 v[44:45], v1 offset:18432
    v_mfma_f32_16x16x32_bf16 v[8:11], v[232:235], v[212:215], v[8:11]
    ds_read_b64_tr_b16 v[46:47], v1 offset:18944
    v_mfma_f32_16x16x32_bf16 v[12:15], v[228:231], v[212:215], v[12:15]
    ds_read_b64_tr_b16 v[80:81], v1 offset:19456
    v_mfma_f32_16x16x32_bf16 v[12:15], v[232:235], v[192:195], v[12:15]
    ds_read_b64_tr_b16 v[82:83], v1 offset:19968
    v_mfma_f32_16x16x32_bf16 v[16:19], v[228:231], v[192:195], v[16:19]
    v_mfma_f32_16x16x32_bf16 v[16:19], v[232:235], v[196:199], v[16:19]
    ds_read_b128 v[52:55], v2 offset:21440
    v_mfma_f32_16x16x32_bf16 v[28:31], v[228:231], v[216:219], v[28:31]
    s_waitcnt lgkmcnt(3)
    ds_read_b128 v[60:63], v2 offset:21568
    v_mfma_f32_16x16x32_bf16 v[28:31], v[232:235], v[244:247], v[28:31]
    v_mfma_f32_16x16x32_bf16 v[32:35], v[228:231], v[244:247], v[32:35]
    ds_read_b128 v[96:99], v2 offset:21952
    v_mfma_f32_16x16x32_bf16 v[32:35], v[232:235], v[248:251], v[32:35]
    ds_read_b128 v[112:115], v2 offset:25984
    v_mfma_f32_16x16x32_bf16 v[4:7], v[44:47], v[212:215], v[4:7]
    s_waitcnt lgkmcnt(3)
    ds_read_b128 v[84:87], v2 offset:22080
    v_mfma_f32_16x16x32_bf16 v[4:7], v[80:83], v[192:195], v[4:7]
    s_barrier
    v_mfma_f32_16x16x32_bf16 v[8:11], v[44:47], v[192:195], v[8:11]
    ds_read_b64_tr_b16 v[128:129], v1 offset:20480
    v_mfma_f32_16x16x32_bf16 v[8:11], v[80:83], v[196:199], v[8:11]
    ds_read_b64_tr_b16 v[130:131], v1 offset:20992
    v_mfma_f32_16x16x32_bf16 v[12:15], v[44:47], v[196:199], v[12:15]
    ds_read_b64_tr_b16 v[132:133], v1 offset:21504
    v_mfma_f32_16x16x32_bf16 v[12:15], v[80:83], v[208:211], v[12:15]
    ds_read_b64_tr_b16 v[134:135], v1 offset:22016
    v_mfma_f32_16x16x32_bf16 v[16:19], v[44:47], v[208:211], v[16:19]
L_pad2_3:
    s_cbranch_execz L_main2
    v_mfma_f32_16x16x32_bf16 v[16:19], v[80:83], v[216:219], v[16:19]
    ds_read_b128 v[92:95], v2 offset:21696
    v_mfma_f32_16x16x32_bf16 v[28:31], v[44:47], v[248:251], v[28:31]
    ds_read_b128 v[104:107], v2 offset:21824
    v_mfma_f32_16x16x32_bf16 v[28:31], v[80:83], v[36:39], v[28:31]
    s_barrier
    v_mfma_f32_16x16x32_bf16 v[32:35], v[44:47], v[36:39], v[32:35]
    ds_read_b64_tr_b16 v[108:109], v1 offset:22528
    v_mfma_f32_16x16x32_bf16 v[32:35], v[80:83], v[68:71], v[32:35]
    s_waitcnt lgkmcnt(3)
    ds_read_b64_tr_b16 v[110:111], v1 offset:23040
    v_mfma_f32_16x16x32_bf16 v[12:15], v[128:131], v[216:219], v[12:15]
    ds_read_b64_tr_b16 v[120:121], v1 offset:23552
    v_mfma_f32_16x16x32_bf16 v[12:15], v[132:135], v[52:55], v[12:15]
    ds_read_b64_tr_b16 v[122:123], v1 offset:24064
    v_mfma_f32_16x16x32_bf16 v[16:19], v[128:131], v[244:247], v[16:19]
    v_mfma_f32_16x16x32_bf16 v[16:19], v[132:135], v[60:63], v[16:19]
    ds_read_b128 v[140:143], v2 offset:23296
    v_mfma_f32_16x16x32_bf16 v[28:31], v[128:131], v[68:71], v[28:31]
    ds_read_b128 v[160:163], v2 offset:23424
    v_mfma_f32_16x16x32_bf16 v[28:31], v[132:135], v[96:99], v[28:31]
    s_barrier
    v_mfma_f32_16x16x32_bf16 v[32:35], v[128:131], v[112:115], v[32:35]
    ds_read_b64_tr_b16 v[164:165], v1 offset:0
    v_mfma_f32_16x16x32_bf16 v[32:35], v[132:135], v[84:87], v[32:35]
    s_waitcnt lgkmcnt(3)
    ds_read_b64_tr_b16 v[166:167], v1 offset:512
    v_mfma_f32_16x16x32_bf16 v[12:15], v[108:111], v[60:63], v[12:15]
    ds_read_b64_tr_b16 v[124:125], v1 offset:1024
    v_mfma_f32_16x16x32_bf16 v[12:15], v[120:123], v[92:95], v[12:15]
    ds_read_b64_tr_b16 v[126:127], v1 offset:1536
    v_mfma_f32_16x16x32_bf16 v[16:19], v[108:111], v[92:95], v[16:19]
    v_mfma_f32_16x16x32_bf16 v[16:19], v[120:123], v[104:107], v[16:19]
    ds_read_b128 v[152:155], v2 offset:23552
    v_mfma_f32_16x16x32_bf16 v[28:31], v[108:111], v[84:87], v[28:31]
    s_waitcnt lgkmcnt(3)
    ds_read_b128 v[156:159], v2 offset:23680
    v_mfma_f32_16x16x32_bf16 v[28:31], v[120:123], v[140:143], v[28:31]
    s_barrier
    v_mfma_f32_16x16x32_bf16 v[32:35], v[108:111], v[140:143], v[32:35]
    ds_read_b64_tr_b16 v[180:181], v1 offset:2048
    v_mfma_f32_16x16x32_bf16 v[32:35], v[120:123], v[160:163], v[32:35]
    ds_read_b64_tr_b16 v[182:183], v1 offset:2560
    v_mfma_f32_16x16x32_bf16 v[12:15], v[164:167], v[104:107], v[12:15]
    s_waitcnt lgkmcnt(3)
    ds_read_b64_tr_b16 v[212:213], v1 offset:3072
    v_mfma_f32_16x16x32_bf16 v[12:15], v[124:127], v[96:99], v[12:15]
    ds_read_b64_tr_b16 v[214:215], v1 offset:3584
    v_mfma_f32_16x16x32_bf16 v[16:19], v[164:167], v[96:99], v[16:19]
    v_mfma_f32_16x16x32_bf16 v[16:19], v[124:127], v[84:87], v[16:19]
    ds_read_b128 v[192:195], v2 offset:23808
    v_mfma_f32_16x16x32_bf16 v[28:31], v[164:167], v[160:163], v[28:31]
    ds_read_b128 v[196:199], v2 offset:23936
    v_mfma_f32_16x16x32_bf16 v[28:31], v[124:127], v[152:155], v[28:31]
    s_barrier
    v_mfma_f32_16x16x32_bf16 v[32:35], v[164:167], v[152:155], v[32:35]
    s_waitcnt lgkmcnt(2)
    ds_read_b64_tr_b16 v[208:209], v1 offset:4096
    v_mfma_f32_16x16x32_bf16 v[32:35], v[124:127], v[156:159], v[32:35]
    ds_read_b64_tr_b16 v[210:211], v1 offset:4608
    v_mfma_f32_16x16x32_bf16 v[12:15], v[180:183], v[84:87], v[12:15]
    ds_read_b64_tr_b16 v[248:249], v1 offset:5120
    v_mfma_f32_16x16x32_bf16 v[12:15], v[212:215], v[140:143], v[12:15]
    ds_read_b64_tr_b16 v[250:251], v1 offset:5632
    v_mfma_f32_16x16x32_bf16 v[16:19], v[180:183], v[140:143], v[16:19]
    v_mfma_f32_16x16x32_bf16 v[16:19], v[212:215], v[160:163], v[16:19]
    ds_read_b128 v[36:39], v2 offset:24064
    v_mfma_f32_16x16x32_bf16 v[28:31], v[180:183], v[156:159], v[28:31]
    s_waitcnt lgkmcnt(3)
    ds_read_b128 v[216:219], v2 offset:24192
    v_mfma_f32_16x16x32_bf16 v[28:31], v[212:215], v[192:195], v[28:31]
    s_barrier
    v_mfma_f32_16x16x32_bf16 v[32:35], v[180:183], v[192:195], v[32:35]
    ds_read_b64_tr_b16 v[52:53], v1 offset:6144
    v_mfma_f32_16x16x32_bf16 v[32:35], v[212:215], v[196:199], v[32:35]
    ds_read_b64_tr_b16 v[54:55], v1 offset:6656
    v_mfma_f32_16x16x32_bf16 v[12:15], v[208:211], v[160:163], v[12:15]
    s_waitcnt lgkmcnt(3)
    ds_read_b64_tr_b16 v[244:245], v1 offset:7168
    v_mfma_f32_16x16x32_bf16 v[12:15], v[248:251], v[152:155], v[12:15]
    ds_read_b64_tr_b16 v[246:247], v1 offset:7680
    v_mfma_f32_16x16x32_bf16 v[16:19], v[208:211], v[152:155], v[16:19]
    v_mfma_f32_16x16x32_bf16 v[16:19], v[248:251], v[156:159], v[16:19]
    ds_read_b128 v[68:71], v2 offset:25408
    v_mfma_f32_16x16x32_bf16 v[28:31], v[208:211], v[196:199], v[28:31]
    ds_read_b128 v[112:115], v2 offset:25536
    v_mfma_f32_16x16x32_bf16 v[28:31], v[248:251], v[36:39], v[28:31]
    s_barrier
    v_mfma_f32_16x16x32_bf16 v[32:35], v[208:211], v[36:39], v[32:35]
    s_waitcnt lgkmcnt(2)
    ds_read_b64_tr_b16 v[60:61], v1 offset:8192
    v_mfma_f32_16x16x32_bf16 v[32:35], v[248:251], v[216:219], v[32:35]
    ds_read_b64_tr_b16 v[62:63], v1 offset:8704
    v_mfma_f32_16x16x32_bf16 v[12:15], v[52:55], v[156:159], v[12:15]
    ds_read_b64_tr_b16 v[92:93], v1 offset:9216
    v_mfma_f32_16x16x32_bf16 v[12:15], v[244:247], v[192:195], v[12:15]
    ds_read_b64_tr_b16 v[94:95], v1 offset:9728
    v_mfma_f32_16x16x32_bf16 v[16:19], v[52:55], v[192:195], v[16:19]
    v_mfma_f32_16x16x32_bf16 v[16:19], v[244:247], v[196:199], v[16:19]
    ds_read_b128 v[104:107], v2 offset:25664
    v_mfma_f32_16x16x32_bf16 v[28:31], v[52:55], v[216:219], v[28:31]
    s_waitcnt lgkmcnt(3)
    ds_read_b128 v[96:99], v2 offset:25792
    v_mfma_f32_16x16x32_bf16 v[28:31], v[244:247], v[68:71], v[28:31]
    s_barrier
    v_mfma_f32_16x16x32_bf16 v[32:35], v[52:55], v[68:71], v[32:35]
    ds_read_b64_tr_b16 v[84:85], v1 offset:10240
    v_mfma_f32_16x16x32_bf16 v[32:35], v[244:247], v[112:115], v[32:35]
    ds_read_b64_tr_b16 v[86:87], v1 offset:10752
    v_mfma_f32_16x16x32_bf16 v[12:15], v[60:63], v[196:199], v[12:15]
    s_waitcnt lgkmcnt(3)
    ds_read_b64_tr_b16 v[140:141], v1 offset:11264
    v_mfma_f32_16x16x32_bf16 v[12:15], v[92:95], v[36:39], v[12:15]
    ds_read_b64_tr_b16 v[142:143], v1 offset:11776
    v_mfma_f32_16x16x32_bf16 v[16:19], v[60:63], v[36:39], v[16:19]
    v_mfma_f32_16x16x32_bf16 v[16:19], v[92:95], v[216:219], v[16:19]
    v_mfma_f32_16x16x32_bf16 v[28:31], v[60:63], v[112:115], v[28:31]
    v_mfma_f32_16x16x32_bf16 v[28:31], v[92:95], v[104:107], v[28:31]
    ds_read_b128 v[160:163], v2 offset:25920
    v_mfma_f32_16x16x32_bf16 v[32:35], v[60:63], v[104:107], v[32:35]
    s_waitcnt lgkmcnt(1)
    ds_read_b128 v[152:155], v2 offset:26048
    v_mfma_f32_16x16x32_bf16 v[32:35], v[92:95], v[96:99], v[32:35]
    ds_read_b128 v[156:159], v2 offset:24000
    v_mfma_f32_16x16x32_bf16 v[12:15], v[84:87], v[216:219], v[12:15]
    v_mfma_f32_16x16x32_bf16 v[12:15], v[140:143], v[68:71], v[12:15]
    ds_read_b128 v[192:195], v2 offset:24128
    v_mfma_f32_16x16x32_bf16 v[16:19], v[84:87], v[68:71], v[16:19]
    ds_read_b128 v[196:199], v2 offset:21184
    v_mfma_f32_16x16x32_bf16 v[16:19], v[140:143], v[112:115], v[16:19]
    s_nop 0
    ds_read_b128 v[36:39], v2 offset:21312
    s_nop 0
    v_mfma_f32_16x16x32_bf16 v[28:31], v[84:87], v[96:99], v[28:31]
    s_waitcnt lgkmcnt(3)
    s_nop 1
    v_mfma_f32_16x16x32_bf16 v[28:31], v[140:143], v[160:163], v[28:31]
    ds_read_b128 v[104:107], v2 offset:21440
    v_cvt_pk_bf16_f32 v12, v12, v13
    v_mfma_f32_16x16x32_bf16 v[32:35], v[84:87], v[160:163], v[32:35]
    v_cvt_pk_bf16_f32 v13, v14, v15
    v_cvt_pk_bf16_f32 v14, v16, v17
    v_mfma_f32_16x16x32_bf16 v[32:35], v[140:143], v[152:155], v[32:35]
    ds_read_b128 v[216:219], v2 offset:21568
    v_cvt_pk_bf16_f32 v15, v18, v19
    v_mfma_f32_16x16x32_bf16 v[4:7], v[128:131], v[156:159], v[4:7]
    s_waitcnt lgkmcnt(2)
    v_min_u32 v12, -2, v12
    v_min_u32 v13, -2, v13
    v_mfma_f32_16x16x32_bf16 v[8:11], v[128:131], v[192:195], v[8:11]
    ds_read_b128 v[68:71], v2 offset:21696
    v_min_u32 v14, -2, v14
L_pad2_4:
    s_cbranch_execz L_main2
    v_mfma_f32_16x16x32_bf16 v[4:7], v[132:135], v[196:199], v[4:7]
    v_min_u32 v15, -2, v15
    v_mfma_f32_16x16x32_bf16 v[4:7], v[108:111], v[36:39], v[4:7]
    buffer_store_dwordx4 v[12:15], v3, s[28:31], s41 offen sc1
    ds_read_b128 v[112:115], v2 offset:21824
    v_cvt_pk_bf16_f32 v28, v28, v29
    v_cvt_pk_bf16_f32 v29, v30, v31
    v_cvt_pk_bf16_f32 v30, v32, v33
    v_mfma_f32_16x16x32_bf16 v[8:11], v[132:135], v[36:39], v[8:11]
    s_waitcnt lgkmcnt(2)
    v_cvt_pk_bf16_f32 v31, v34, v35
    v_min_u32 v28, -2, v28
    v_mfma_f32_16x16x32_bf16 v[8:11], v[108:111], v[104:107], v[8:11]
    ds_read_b128 v[96:99], v2 offset:21952
    v_min_u32 v29, -2, v29
    v_mfma_f32_16x16x32_bf16 v[4:7], v[120:123], v[104:107], v[4:7]
    v_min_u32 v30, -2, v30
    v_min_u32 v31, -2, v31
    v_mfma_f32_16x16x32_bf16 v[4:7], v[164:167], v[216:219], v[4:7]
    buffer_store_dwordx4 v[28:31], v3, s[28:31], s43 offen sc1
    ds_read_b128 v[160:163], v2 offset:22080
    v_mfma_f32_16x16x32_bf16 v[8:11], v[120:123], v[216:219], v[8:11]
    s_waitcnt lgkmcnt(2)
    v_mfma_f32_16x16x32_bf16 v[8:11], v[164:167], v[68:71], v[8:11]
    ds_read_b128 v[152:155], v2 offset:23296
    v_mfma_f32_16x16x32_bf16 v[4:7], v[124:127], v[68:71], v[4:7]
    v_mfma_f32_16x16x32_bf16 v[4:7], v[180:183], v[112:115], v[4:7]
    ds_read_b128 v[156:159], v2 offset:23424
    v_mfma_f32_16x16x32_bf16 v[8:11], v[124:127], v[112:115], v[8:11]
    s_waitcnt lgkmcnt(2)
    v_mfma_f32_16x16x32_bf16 v[8:11], v[180:183], v[96:99], v[8:11]
    ds_read_b128 v[192:195], v2 offset:23552
    v_mfma_f32_16x16x32_bf16 v[4:7], v[212:215], v[96:99], v[4:7]
    v_mfma_f32_16x16x32_bf16 v[4:7], v[208:211], v[160:163], v[4:7]
    ds_read_b128 v[196:199], v2 offset:23680
    v_mfma_f32_16x16x32_bf16 v[8:11], v[212:215], v[160:163], v[8:11]
    s_waitcnt lgkmcnt(2)
    v_mfma_f32_16x16x32_bf16 v[8:11], v[208:211], v[152:155], v[8:11]
    ds_read_b128 v[36:39], v2 offset:23808
    v_mfma_f32_16x16x32_bf16 v[4:7], v[248:251], v[152:155], v[4:7]
    v_mfma_f32_16x16x32_bf16 v[4:7], v[52:55], v[156:159], v[4:7]
    ds_read_b128 v[104:107], v2 offset:23936
    v_mfma_f32_16x16x32_bf16 v[8:11], v[248:251], v[156:159], v[8:11]
    s_waitcnt lgkmcnt(2)
    v_mfma_f32_16x16x32_bf16 v[8:11], v[52:55], v[192:195], v[8:11]
    ds_read_b128 v[216:219], v2 offset:24064
    v_mfma_f32_16x16x32_bf16 v[4:7], v[244:247], v[192:195], v[4:7]
    v_mfma_f32_16x16x32_bf16 v[4:7], v[60:63], v[196:199], v[4:7]
    ds_read_b128 v[68:71], v2 offset:24192
    v_mfma_f32_16x16x32_bf16 v[8:11], v[244:247], v[196:199], v[8:11]
    s_waitcnt lgkmcnt(2)
    ds_read_b128 v[112:115], v2 offset:704
    v_mfma_f32_16x16x32_bf16 v[8:11], v[60:63], v[36:39], v[8:11]
    ds_read_b128 v[96:99], v2 offset:832
    v_mfma_f32_16x16x32_bf16 v[4:7], v[92:95], v[36:39], v[4:7]
    v_mfma_f32_16x16x32_bf16 v[4:7], v[84:87], v[104:107], v[4:7]
    ds_read_b128 v[160:163], v2 offset:960
    v_mfma_f32_16x16x32_bf16 v[8:11], v[92:95], v[104:107], v[8:11]
    s_waitcnt lgkmcnt(3)
    v_mfma_f32_16x16x32_bf16 v[8:11], v[84:87], v[216:219], v[8:11]
    ds_read_b128 v[152:155], v2 offset:2176
    v_mfma_f32_16x16x32_bf16 v[4:7], v[140:143], v[216:219], v[4:7]
    v_mfma_f32_16x16x32_bf16 v[8:11], v[140:143], v[68:71], v[8:11]
    s_waitcnt lgkmcnt(2)
    ds_read_b128 v[156:159], v2 offset:2304
    s_nop 0
    v_mfma_f32_16x16x32_bf16 v[20:23], v[220:223], v[112:115], v[20:23]
    s_nop 0
    s_nop 1
    v_mfma_f32_16x16x32_bf16 v[20:23], v[224:227], v[96:99], v[20:23]
    ds_read_b128 v[192:195], v2 offset:2432
    v_cvt_pk_bf16_f32 v4, v4, v5
    v_mfma_f32_16x16x32_bf16 v[24:27], v[220:223], v[96:99], v[24:27]
    s_waitcnt lgkmcnt(2)
    v_cvt_pk_bf16_f32 v5, v6, v7
    v_cvt_pk_bf16_f32 v6, v8, v9
    v_mfma_f32_16x16x32_bf16 v[24:27], v[224:227], v[160:163], v[24:27]
    ds_read_b128 v[196:199], v2 offset:2560
    v_cvt_pk_bf16_f32 v7, v10, v11
    v_mfma_f32_16x16x32_bf16 v[20:23], v[236:239], v[160:163], v[20:23]
    v_min_u32 v4, -2, v4
    v_min_u32 v5, -2, v5
    v_mfma_f32_16x16x32_bf16 v[20:23], v[240:243], v[152:155], v[20:23]
    ds_read_b128 v[36:39], v2 offset:2688
    v_min_u32 v6, -2, v6
    v_mfma_f32_16x16x32_bf16 v[24:27], v[236:239], v[152:155], v[24:27]
    s_waitcnt lgkmcnt(2)
    v_min_u32 v7, -2, v7
    v_mfma_f32_16x16x32_bf16 v[24:27], v[240:243], v[156:159], v[24:27]
    buffer_store_dwordx4 v[4:7], v3, s[28:31], s40 offen sc1
    ds_read_b128 v[104:107], v2 offset:2816
    v_and_b32 v32, 15, v0
    v_lshrrev_b32 v8, 4, v0
    v_mad_u32_u24 v9, v32, 17, v8
    v_mfma_f32_16x16x32_bf16 v[20:23], v[252:255], v[156:159], v[20:23]
    s_lshl_b32 s12, s10, 6
    s_add_u32 s12, s12, 140544
    v_lshl_add_u32 v9, v9, 4, s12
    v_mfma_f32_16x16x32_bf16 v[20:23], v[40:43], v[192:195], v[20:23]
    ds_read_b128 v[216:219], v2 offset:2944
    v_mad_u32_u24 v10, v8, 17, v32
    v_mfma_f32_16x16x32_bf16 v[24:27], v[252:255], v[192:195], v[24:27]
    s_waitcnt lgkmcnt(2)
    s_mul_i32 s12, s10, 1088
    s_add_u32 s12, s12, 144896
    v_mfma_f32_16x16x32_bf16 v[24:27], v[40:43], v[196:199], v[24:27]
    ds_read_b128 v[68:71], v2 offset:3072
    v_lshl_add_u32 v10, v10, 4, s12
    v_mfma_f32_16x16x32_bf16 v[20:23], v[72:75], v[196:199], v[20:23]
    v_mul_u32_u24 v8, 9, v8
    v_and_b32 v8, 17, v8
    v_mfma_f32_16x16x32_bf16 v[20:23], v[48:51], v[36:39], v[20:23]
    s_lshl2_add_u32 s12, s7, s10
    ds_read_b128 v[112:115], v2 offset:4288
    s_lshl3_add_u32 s12, s12, s4
    v_mfma_f32_16x16x32_bf16 v[24:27], v[72:75], v[36:39], v[24:27]
    s_waitcnt lgkmcnt(2)
    s_lshl4_add_u32 s12, s12, s6
    s_add_u32 s12, s12, 8
    v_mfma_f32_16x16x32_bf16 v[24:27], v[48:51], v[104:107], v[24:27]
    s_lshl_b32 s12, s12, 7
    ds_read_b128 v[220:223], v2 offset:4416
    v_lshl_add_u32 v11, v8, 6, v32
    v_mfma_f32_16x16x32_bf16 v[20:23], v[88:91], v[104:107], v[20:23]
    v_lshl_add_u32 v11, v11, 3, s12
    v_mfma_f32_16x16x32_bf16 v[20:23], v[56:59], v[216:219], v[20:23]
    ds_read_b128 v[96:99], v2 offset:4544
    v_mfma_f32_16x16x32_bf16 v[24:27], v[88:91], v[216:219], v[24:27]
    s_waitcnt lgkmcnt(2)
    ds_read_b128 v[224:227], v2 offset:4672
    v_mfma_f32_16x16x32_bf16 v[24:27], v[56:59], v[68:71], v[24:27]
    v_mfma_f32_16x16x32_bf16 v[20:23], v[100:103], v[68:71], v[20:23]
    ds_read_b128 v[160:163], v2 offset:21632
    v_mfma_f32_16x16x32_bf16 v[20:23], v[64:67], v[112:115], v[20:23]
    ds_read_b128 v[236:239], v2 offset:21760
    v_mfma_f32_16x16x32_bf16 v[24:27], v[100:103], v[112:115], v[24:27]
    s_waitcnt lgkmcnt(3)
    ds_read_b128 v[152:155], v2 offset:21888
    v_mfma_f32_16x16x32_bf16 v[24:27], v[64:67], v[220:223], v[24:27]
    s_barrier
    v_mfma_f32_16x16x32_bf16 v[20:23], v[116:119], v[220:223], v[20:23]
    v_mfma_f32_16x16x32_bf16 v[20:23], v[76:79], v[96:99], v[20:23]
    ds_read_b128 v[240:243], v2 offset:22016
    v_mfma_f32_16x16x32_bf16 v[24:27], v[116:119], v[96:99], v[24:27]
    s_waitcnt lgkmcnt(2)
    v_mfma_f32_16x16x32_bf16 v[24:27], v[76:79], v[224:227], v[24:27]
    ds_read_b128 v[156:159], v2 offset:23232
    v_mfma_f32_16x16x32_bf16 v[20:23], v[144:147], v[160:163], v[20:23]
L_pad2_5:
    s_cbranch_execz L_main2
    v_mfma_f32_16x16x32_bf16 v[20:23], v[148:151], v[236:239], v[20:23]
    ds_read_b128 v[252:255], v2 offset:23360
    v_mfma_f32_16x16x32_bf16 v[24:27], v[144:147], v[236:239], v[24:27]
    s_waitcnt lgkmcnt(2)
    v_mfma_f32_16x16x32_bf16 v[24:27], v[148:151], v[152:155], v[24:27]
    ds_read_b128 v[192:195], v2 offset:23488
    v_mfma_f32_16x16x32_bf16 v[20:23], v[176:179], v[152:155], v[20:23]
    v_mfma_f32_16x16x32_bf16 v[20:23], v[136:139], v[240:243], v[20:23]
    ds_read_b128 v[40:43], v2 offset:23616
    v_mfma_f32_16x16x32_bf16 v[24:27], v[176:179], v[240:243], v[24:27]
    s_waitcnt lgkmcnt(2)
    v_mfma_f32_16x16x32_bf16 v[24:27], v[136:139], v[156:159], v[24:27]
    ds_read_b128 v[196:199], v2 offset:23744
    v_mfma_f32_16x16x32_bf16 v[20:23], v[168:171], v[156:159], v[20:23]
    v_mfma_f32_16x16x32_bf16 v[20:23], v[172:175], v[252:255], v[20:23]
    ds_read_b128 v[72:75], v2 offset:23872
    v_mfma_f32_16x16x32_bf16 v[24:27], v[168:171], v[252:255], v[24:27]
    s_waitcnt lgkmcnt(2)
    v_mfma_f32_16x16x32_bf16 v[24:27], v[172:175], v[192:195], v[24:27]
    ds_read_b128 v[36:39], v2 offset:24000
    v_mfma_f32_16x16x32_bf16 v[20:23], v[184:187], v[192:195], v[20:23]
    v_mfma_f32_16x16x32_bf16 v[20:23], v[188:191], v[40:43], v[20:23]
    ds_read_b128 v[48:51], v2 offset:24128
    v_mfma_f32_16x16x32_bf16 v[24:27], v[184:187], v[40:43], v[24:27]
    s_waitcnt lgkmcnt(2)
    v_mfma_f32_16x16x32_bf16 v[24:27], v[188:191], v[196:199], v[24:27]
    ds_read_b128 v[104:107], v2 offset:25344
    v_mfma_f32_16x16x32_bf16 v[20:23], v[200:203], v[196:199], v[20:23]
    v_mfma_f32_16x16x32_bf16 v[20:23], v[204:207], v[72:75], v[20:23]
    ds_read_b128 v[88:91], v2 offset:25472
    v_mfma_f32_16x16x32_bf16 v[24:27], v[200:203], v[72:75], v[24:27]
    s_waitcnt lgkmcnt(2)
    ds_read_b128 v[216:219], v2 offset:25600
    v_mfma_f32_16x16x32_bf16 v[24:27], v[204:207], v[36:39], v[24:27]
    v_mfma_f32_16x16x32_bf16 v[20:23], v[228:231], v[36:39], v[20:23]
    ds_read_b128 v[56:59], v2 offset:25728
    v_mfma_f32_16x16x32_bf16 v[20:23], v[232:235], v[48:51], v[20:23]
    ds_read_b128 v[68:71], v2 offset:21696
    v_mfma_f32_16x16x32_bf16 v[24:27], v[228:231], v[48:51], v[24:27]
    s_waitcnt lgkmcnt(3)
    ds_read_b128 v[100:103], v2 offset:21824
    v_mfma_f32_16x16x32_bf16 v[24:27], v[232:235], v[104:107], v[24:27]
    buffer_load_dwordx4 v[112:115], v3, s[28:31], s44 offen sc1
    v_mfma_f32_16x16x32_bf16 v[20:23], v[44:47], v[104:107], v[20:23]
    v_mfma_f32_16x16x32_bf16 v[20:23], v[80:83], v[88:91], v[20:23]
    ds_read_b128 v[64:67], v2 offset:21952
    v_mfma_f32_16x16x32_bf16 v[24:27], v[44:47], v[88:91], v[24:27]
    s_waitcnt lgkmcnt(2)
    v_mfma_f32_16x16x32_bf16 v[24:27], v[80:83], v[216:219], v[24:27]
    ds_read_b128 v[220:223], v2 offset:22080
    v_mfma_f32_16x16x32_bf16 v[20:23], v[128:131], v[216:219], v[20:23]
    v_mfma_f32_16x16x32_bf16 v[24:27], v[128:131], v[56:59], v[24:27]
    ds_read_b128 v[116:119], v2 offset:23296
    v_mfma_f32_16x16x32_bf16 v[20:23], v[132:135], v[68:71], v[20:23]
    s_waitcnt lgkmcnt(2)
    v_mfma_f32_16x16x32_bf16 v[20:23], v[108:111], v[100:103], v[20:23]
    ds_read_b128 v[96:99], v2 offset:23424
    v_mfma_f32_16x16x32_bf16 v[24:27], v[132:135], v[100:103], v[24:27]
    v_mfma_f32_16x16x32_bf16 v[24:27], v[108:111], v[64:67], v[24:27]
    ds_read_b128 v[76:79], v2 offset:23552
    v_mfma_f32_16x16x32_bf16 v[20:23], v[120:123], v[64:67], v[20:23]
    s_waitcnt lgkmcnt(2)
    v_mfma_f32_16x16x32_bf16 v[20:23], v[164:167], v[220:223], v[20:23]
    ds_read_b128 v[224:227], v2 offset:23680
    v_mfma_f32_16x16x32_bf16 v[24:27], v[120:123], v[220:223], v[24:27]
    v_mfma_f32_16x16x32_bf16 v[24:27], v[164:167], v[116:119], v[24:27]
    ds_read_b128 v[160:163], v2 offset:23808
    v_mfma_f32_16x16x32_bf16 v[20:23], v[124:127], v[116:119], v[20:23]
    s_waitcnt lgkmcnt(2)
    v_mfma_f32_16x16x32_bf16 v[20:23], v[180:183], v[96:99], v[20:23]
    ds_read_b128 v[144:147], v2 offset:23936
    v_mfma_f32_16x16x32_bf16 v[24:27], v[124:127], v[96:99], v[24:27]
    v_mfma_f32_16x16x32_bf16 v[24:27], v[180:183], v[76:79], v[24:27]
    ds_read_b128 v[236:239], v2 offset:24064
    v_mfma_f32_16x16x32_bf16 v[20:23], v[212:215], v[76:79], v[20:23]
    s_waitcnt lgkmcnt(2)
    v_mfma_f32_16x16x32_bf16 v[20:23], v[208:211], v[224:227], v[20:23]
    ds_read_b128 v[148:151], v2 offset:24192
    v_mfma_f32_16x16x32_bf16 v[24:27], v[212:215], v[224:227], v[24:27]
    v_mfma_f32_16x16x32_bf16 v[24:27], v[208:211], v[160:163], v[24:27]
    ds_read_b128 v[152:155], v2 offset:25408
    v_mfma_f32_16x16x32_bf16 v[20:23], v[248:251], v[160:163], v[20:23]
    s_waitcnt lgkmcnt(2)
    v_mfma_f32_16x16x32_bf16 v[20:23], v[52:55], v[144:147], v[20:23]
    ds_read_b128 v[176:179], v2 offset:25536
    v_mfma_f32_16x16x32_bf16 v[24:27], v[248:251], v[144:147], v[24:27]
    v_mfma_f32_16x16x32_bf16 v[24:27], v[52:55], v[236:239], v[24:27]
    ds_read_b128 v[240:243], v2 offset:25664
    v_mfma_f32_16x16x32_bf16 v[20:23], v[244:247], v[236:239], v[20:23]
    s_waitcnt lgkmcnt(2)
    v_mfma_f32_16x16x32_bf16 v[20:23], v[60:63], v[148:151], v[20:23]
    ds_read_b128 v[136:139], v2 offset:25792
    v_mfma_f32_16x16x32_bf16 v[24:27], v[244:247], v[148:151], v[24:27]
    v_mfma_f32_16x16x32_bf16 v[24:27], v[60:63], v[152:155], v[24:27]
    v_mfma_f32_16x16x32_bf16 v[20:23], v[92:95], v[152:155], v[20:23]
    s_waitcnt lgkmcnt(1)
    v_mfma_f32_16x16x32_bf16 v[20:23], v[84:87], v[176:179], v[20:23]
    v_mfma_f32_16x16x32_bf16 v[24:27], v[92:95], v[176:179], v[24:27]
    v_mfma_f32_16x16x32_bf16 v[24:27], v[84:87], v[240:243], v[24:27]
    v_mfma_f32_16x16x32_bf16 v[20:23], v[140:143], v[240:243], v[20:23]
    s_waitcnt lgkmcnt(0)
    s_waitcnt vmcnt(0)
    v_max3_u32 v156, v112, v113, v114
    v_mfma_f32_16x16x32_bf16 v[24:27], v[140:143], v[136:139], v[24:27]
    v_max_u32 v156, v156, v115
    v_cmp_eq_u32 vcc, -1, v156
    s_cbranch_vccnz L_again2
L_fin2:
    v_lshlrev_b32 v156, 16, v112
    v_and_b32 v157, s38, v112
    v_lshlrev_b32 v158, 16, v113
    v_and_b32 v159, s38, v113
    v_lshlrev_b32 v168, 16, v114
    v_and_b32 v169, s38, v114
    v_lshlrev_b32 v170, 16, v115
    v_and_b32 v171, s38, v115
    v_pk_add_f32 v[156:157], v[156:157], v[20:21]
    v_pk_add_f32 v[158:159], v[158:159], v[22:23]
    v_pk_mul_f32 v[156:157], v[156:157], s[36:37]
    v_pk_mul_f32 v[158:159], v[158:159], s[36:37]
    v_exp_f32 v156, v156
    v_exp_f32 v157, v157
    v_exp_f32 v158, v158
    v_exp_f32 v159, v159
    v_pk_add_f32 v[168:169], v[168:169], v[24:25]
    v_pk_add_f32 v[170:171], v[170:171], v[26:27]
    v_pk_mul_f32 v[168:169], v[168:169], s[36:37]
    v_pk_mul_f32 v[170:171], v[170:171], s[36:37]
    v_pk_add_f32 v[156:157], v[156:157], 1.0 op_sel_hi:[1,0]
    v_pk_add_f32 v[158:159], v[158:159], 1.0 op_sel_hi:[1,0]
    v_rcp_f32 v156, v156
    v_rcp_f32 v157, v157
    v_rcp_f32 v158, v158
    v_rcp_f32 v159, v159
    v_exp_f32 v168, v168
    v_exp_f32 v169, v169
    v_exp_f32 v170, v170
    v_exp_f32 v171, v171
    ds_write_b128 v9, v[156:159] offset:0
    v_pk_add_f32 v[168:169], v[168:169], 1.0 op_sel_hi:[1,0]
    v_pk_add_f32 v[170:171], v[170:171], 1.0 op_sel_hi:[1,0]
    v_rcp_f32 v168, v168
    v_rcp_f32 v169, v169
    v_rcp_f32 v170, v170
    v_rcp_f32 v171, v171
    s_nop 0
    ds_write_b128 v9, v[168:171] offset:4352
    s_waitcnt lgkmcnt(0)
    s_barrier
    ds_read_b128 v[252:255], v10
    ds_read_b128 v[172:175], v10 offset:8704
    s_waitcnt lgkmcnt(0)
    v_pk_mul_f32 v[252:253], v[252:253], v[172:173]
    v_pk_mul_f32 v[254:255], v[254:255], v[174:175]
    v_pk_fma_f32 v[252:253], v[252:253], -2.0, v[172:173] op_sel_hi:[1,0,1]
    v_pk_fma_f32 v[254:255], v[254:255], -2.0, v[174:175] op_sel_hi:[1,0,1]
    v_cvt_pk_bf16_f32 v252, v252, v253
    v_cvt_pk_bf16_f32 v253, v254, v255
    buffer_store_dwordx2 v[252:253], v11, s[24:27], 0 offen
    s_endpgm
L_again2:
    s_add_u32 s13, s13, 1
    s_cmp_ge_u32 s13, 200000
    s_cbranch_scc1 L_fin2
    buffer_load_dwordx4 v[112:115], v3, s[28:31], s44 offen sc1
    s_waitcnt vmcnt(0)
    v_max3_u32 v156, v112, v113, v114
    v_max_u32 v156, v156, v115
    v_cmp_eq_u32 vcc, -1, v156
    s_cbranch_vccnz L_again2
    s_branch L_fin2
.p2align 12
L_role3:
    s_load_dwordx2 s[28:29], s[0:1], 32
    s_load_dwordx2 s[24:25], s[0:1], 16
    s_cmp_eq_u32 s10, 1
    s_cbranch_scc1 L_pad3_0
    s_cmp_eq_u32 s10, 2
    s_cbranch_scc1 L_pad3_1
    s_cmp_eq_u32 s10, 3
    s_cbranch_scc1 L_pad3_2
L_main3:
    s_mov_b64 exec, -1
    s_setprio 1
    s_waitcnt vmcnt(0) lgkmcnt(0)
    s_barrier
    ds_read_b64_tr_b16 v[36:37], v1 offset:0
    ds_read_b64_tr_b16 v[38:39], v1 offset:512
    ds_read_b128 v[40:43], v2 offset:0
    ds_read_b128 v[44:47], v2 offset:128
    ds_read_b128 v[48:51], v2 offset:256
    ds_read_b128 v[52:55], v2 offset:384
    ds_read_b128 v[56:59], v2 offset:512
    ds_read_b128 v[60:63], v2 offset:640
    s_waitcnt lgkmcnt(5)
    v_mfma_f32_16x16x32_bf16 v[4:7], v[36:39], v[40:43], 0
    s_waitcnt lgkmcnt(4)
    ds_read_b128 v[64:67], v2 offset:768
    v_mfma_f32_16x16x32_bf16 v[8:11], v[36:39], v[44:47], 0
    s_waitcnt lgkmcnt(4)
    ds_read_b128 v[68:71], v2 offset:896
    v_mfma_f32_16x16x32_bf16 v[12:15], v[36:39], v[48:51], 0
    s_waitcnt lgkmcnt(4)
    v_mfma_f32_16x16x32_bf16 v[16:19], v[36:39], v[52:55], 0
    s_waitcnt lgkmcnt(3)
    s_barrier
    ds_read_b64_tr_b16 v[72:73], v1 offset:1024
    v_mfma_f32_16x16x32_bf16 v[20:23], v[36:39], v[56:59], 0
    s_waitcnt lgkmcnt(3)
    ds_read_b64_tr_b16 v[74:75], v1 offset:1536
    v_mfma_f32_16x16x32_bf16 v[24:27], v[36:39], v[60:63], 0
    s_waitcnt lgkmcnt(3)
    ds_read_b128 v[76:79], v2 offset:2112
    v_mfma_f32_16x16x32_bf16 v[28:31], v[36:39], v[64:67], 0
    s_waitcnt lgkmcnt(3)
    s_barrier
    v_mfma_f32_16x16x32_bf16 v[32:35], v[36:39], v[68:71], 0
    s_waitcnt lgkmcnt(1)
    ds_read_b64_tr_b16 v[80:81], v1 offset:2048
    v_mfma_f32_16x16x32_bf16 v[4:7], v[72:75], v[44:47], v[4:7]
    ds_read_b64_tr_b16 v[82:83], v1 offset:2560
    v_mfma_f32_16x16x32_bf16 v[8:11], v[72:75], v[48:51], v[8:11]
    v_mfma_f32_16x16x32_bf16 v[12:15], v[72:75], v[52:55], v[12:15]
    v_mfma_f32_16x16x32_bf16 v[16:19], v[72:75], v[56:59], v[16:19]
    v_mfma_f32_16x16x32_bf16 v[20:23], v[72:75], v[60:63], v[20:23]
    v_mfma_f32_16x16x32_bf16 v[24:27], v[72:75], v[64:67], v[24:27]
    s_lshr_b32 s9, s2, 2
    ds_read_b128 v[84:87], v2 offset:2240
    s_and_b32 s6, s9, 3
    v_mfma_f32_16x16x32_bf16 v[28:31], v[72:75], v[68:71], v[28:31]
    s_waitcnt lgkmcnt(1)
    s_barrier
    v_mfma_f32_16x16x32_bf16 v[32:35], v[72:75], v[76:79], v[32:35]
    s_lshr_b32 s7, s2, 5
    ds_read_b64_tr_b16 v[88:89], v1 offset:3072
    s_mov_b32 s26, 512000
    v_mfma_f32_16x16x32_bf16 v[4:7], v[80:83], v[48:51], v[4:7]
    s_mov_b32 s27, 0x20000
    ds_read_b64_tr_b16 v[90:91], v1 offset:3584
    s_bitcmp1_b32 s2, 4
    v_mfma_f32_16x16x32_bf16 v[8:11], v[80:83], v[52:55], v[8:11]
    s_cselect_b32 s8, s26, 0
    s_mov_b32 s30, 3162112
    s_mov_b32 s31, s27
    v_mfma_f32_16x16x32_bf16 v[12:15], v[80:83], v[56:59], v[12:15]
    s_lshl_b32 s12, s10, 10
    v_lshl_add_u32 v3, v0, 4, s12
    s_mul_i32 s12, s9, 49408
    v_mfma_f32_16x16x32_bf16 v[16:19], v[80:83], v[60:63], v[16:19]
    s_add_u32 s40, s12, 8192
    s_add_u32 s41, s12, 16384
    s_add_u32 s42, s12, 24576
    v_mfma_f32_16x16x32_bf16 v[20:23], v[80:83], v[64:67], v[20:23]
    s_add_u32 s44, s12, 40960
    ds_read_b128 v[92:95], v2 offset:2368
    s_mov_b32 s13, 0
    v_mfma_f32_16x16x32_bf16 v[24:27], v[80:83], v[68:71], v[24:27]
    s_barrier
    s_mov_b32 s38, 0xffff0000
    v_mfma_f32_16x16x32_bf16 v[28:31], v[80:83], v[76:79], v[28:31]
    s_waitcnt lgkmcnt(1)
    ds_read_b64_tr_b16 v[96:97], v1 offset:4096
    s_mov_b32 s36, 0xbfb8aa3b
    v_mfma_f32_16x16x32_bf16 v[32:35], v[80:83], v[84:87], v[32:35]
    s_mov_b32 s37, s36
    ds_read_b64_tr_b16 v[98:99], v1 offset:4608
    s_add_u32 s24, s24, s8
    v_mfma_f32_16x16x32_bf16 v[4:7], v[88:91], v[52:55], v[4:7]
    s_addc_u32 s25, s25, 0
    ds_read_b64_tr_b16 v[100:101], v1 offset:5120
    v_mfma_f32_16x16x32_bf16 v[8:11], v[88:91], v[56:59], v[8:11]
    ds_read_b64_tr_b16 v[102:103], v1 offset:5632
    v_mfma_f32_16x16x32_bf16 v[12:15], v[88:91], v[60:63], v[12:15]
    v_mfma_f32_16x16x32_bf16 v[16:19], v[88:91], v[64:67], v[16:19]
    v_mfma_f32_16x16x32_bf16 v[20:23], v[88:91], v[68:71], v[20:23]
    v_mfma_f32_16x16x32_bf16 v[24:27], v[88:91], v[76:79], v[24:27]
    v_mfma_f32_16x16x32_bf16 v[28:31], v[88:91], v[84:87], v[28:31]
    s_waitcnt lgkmcnt(0)
    v_mfma_f32_16x16x32_bf16 v[32:35], v[88:91], v[92:95], v[32:35]
    v_mfma_f32_16x16x32_bf16 v[4:7], v[96:99], v[56:59], v[4:7]
    v_mfma_f32_16x16x32_bf16 v[4:7], v[100:103], v[60:63], v[4:7]
    v_mfma_f32_16x16x32_bf16 v[8:11], v[96:99], v[60:63], v[8:11]
    v_mfma_f32_16x16x32_bf16 v[8:11], v[100:103], v[64:67], v[8:11]
    ds_read_b128 v[104:107], v2 offset:2496
    v_mfma_f32_16x16x32_bf16 v[12:15], v[96:99], v[64:67], v[12:15]
    ds_read_b128 v[108:111], v2 offset:2624
    v_mfma_f32_16x16x32_bf16 v[12:15], v[100:103], v[68:71], v[12:15]
    s_barrier
    v_mfma_f32_16x16x32_bf16 v[16:19], v[96:99], v[68:71], v[16:19]
    ds_read_b64_tr_b16 v[112:113], v1 offset:6144
    v_mfma_f32_16x16x32_bf16 v[16:19], v[100:103], v[76:79], v[16:19]
    ds_read_b64_tr_b16 v[114:115], v1 offset:6656
    v_mfma_f32_16x16x32_bf16 v[20:23], v[96:99], v[76:79], v[20:23]
    ds_read_b64_tr_b16 v[116:117], v1 offset:7168
    v_mfma_f32_16x16x32_bf16 v[20:23], v[100:103], v[84:87], v[20:23]
    ds_read_b64_tr_b16 v[118:119], v1 offset:7680
    v_mfma_f32_16x16x32_bf16 v[24:27], v[96:99], v[84:87], v[24:27]
    v_mfma_f32_16x16x32_bf16 v[24:27], v[100:103], v[92:95], v[24:27]
    v_mfma_f32_16x16x32_bf16 v[28:31], v[96:99], v[92:95], v[28:31]
    s_waitcnt lgkmcnt(2)
    v_mfma_f32_16x16x32_bf16 v[28:31], v[100:103], v[104:107], v[28:31]
    v_mfma_f32_16x16x32_bf16 v[32:35], v[96:99], v[104:107], v[32:35]
    v_mfma_f32_16x16x32_bf16 v[32:35], v[100:103], v[108:111], v[32:35]
    v_mfma_f32_16x16x32_bf16 v[4:7], v[112:115], v[64:67], v[4:7]
    s_waitcnt lgkmcnt(0)
    v_mfma_f32_16x16x32_bf16 v[4:7], v[116:119], v[68:71], v[4:7]
    v_mfma_f32_16x16x32_bf16 v[8:11], v[112:115], v[68:71], v[8:11]
    v_mfma_f32_16x16x32_bf16 v[8:11], v[116:119], v[76:79], v[8:11]
    ds_read_b128 v[120:123], v2 offset:2752
    v_mfma_f32_16x16x32_bf16 v[12:15], v[112:115], v[76:79], v[12:15]
    ds_read_b128 v[124:127], v2 offset:2880
    v_mfma_f32_16x16x32_bf16 v[12:15], v[116:119], v[84:87], v[12:15]
    s_barrier
    v_mfma_f32_16x16x32_bf16 v[16:19], v[112:115], v[84:87], v[16:19]
    ds_read_b64_tr_b16 v[128:129], v1 offset:8192
    v_mfma_f32_16x16x32_bf16 v[16:19], v[116:119], v[92:95], v[16:19]
    ds_read_b64_tr_b16 v[130:131], v1 offset:8704
    v_mfma_f32_16x16x32_bf16 v[20:23], v[112:115], v[92:95], v[20:23]
    ds_read_b64_tr_b16 v[132:133], v1 offset:9216
    v_mfma_f32_16x16x32_bf16 v[20:23], v[116:119], v[104:107], v[20:23]
    ds_read_b64_tr_b16 v[134:135], v1 offset:9728
    v_mfma_f32_16x16x32_bf16 v[24:27], v[112:115], v[104:107], v[24:27]
    v_mfma_f32_16x16x32_bf16 v[24:27], v[116:119], v[108:111], v[24:27]
L_pad3_0:
    s_cbranch_execz L_pad3_3
    v_mfma_f32_16x16x32_bf16 v[28:31], v[112:115], v[108:111], v[28:31]
    s_waitcnt lgkmcnt(2)
    v_mfma_f32_16x16x32_bf16 v[28:31], v[116:119], v[120:123], v[28:31]
    v_mfma_f32_16x16x32_bf16 v[32:35], v[112:115], v[120:123], v[32:35]
    v_mfma_f32_16x16x32_bf16 v[32:35], v[116:119], v[124:127], v[32:35]
    v_mfma_f32_16x16x32_bf16 v[4:7], v[128:131], v[76:79], v[4:7]
    s_waitcnt lgkmcnt(0)
    v_mfma_f32_16x16x32_bf16 v[4:7], v[132:135], v[84:87], v[4:7]
    v_mfma_f32_16x16x32_bf16 v[8:11], v[128:131], v[84:87], v[8:11]
    v_mfma_f32_16x16x32_bf16 v[8:11], v[132:135], v[92:95], v[8:11]
    ds_read_b128 v[136:139], v2 offset:3008
    v_mfma_f32_16x16x32_bf16 v[12:15], v[128:131], v[92:95], v[12:15]
    ds_read_b128 v[140:143], v2 offset:4224
    v_mfma_f32_16x16x32_bf16 v[12:15], v[132:135], v[104:107], v[12:15]
    s_barrier
    v_mfma_f32_16x16x32_bf16 v[16:19], v[128:131], v[104:107], v[16:19]
    ds_read_b64_tr_b16 v[144:145], v1 offset:10240
    v_mfma_f32_16x16x32_bf16 v[16:19], v[132:135], v[108:111], v[16:19]
    ds_read_b64_tr_b16 v[146:147], v1 offset:10752
    v_mfma_f32_16x16x32_bf16 v[20:23], v[128:131], v[108:111], v[20:23]
    ds_read_b64_tr_b16 v[148:149], v1 offset:11264
    v_mfma_f32_16x16x32_bf16 v[20:23], v[132:135], v[120:123], v[20:23]
    ds_read_b64_tr_b16 v[150:151], v1 offset:11776
    v_mfma_f32_16x16x32_bf16 v[24:27], v[128:131], v[120:123], v[24:27]
    v_mfma_f32_16x16x32_bf16 v[24:27], v[132:135], v[124:127], v[24:27]
    v_mfma_f32_16x16x32_bf16 v[28:31], v[128:131], v[124:127], v[28:31]
    s_waitcnt lgkmcnt(2)
    v_mfma_f32_16x16x32_bf16 v[28:31], v[132:135], v[136:139], v[28:31]
    v_mfma_f32_16x16x32_bf16 v[32:35], v[128:131], v[136:139], v[32:35]
    v_mfma_f32_16x16x32_bf16 v[32:35], v[132:135], v[140:143], v[32:35]
    v_mfma_f32_16x16x32_bf16 v[4:7], v[144:147], v[92:95], v[4:7]
    s_waitcnt lgkmcnt(0)
    v_mfma_f32_16x16x32_bf16 v[4:7], v[148:151], v[104:107], v[4:7]
    v_mfma_f32_16x16x32_bf16 v[8:11], v[144:147], v[104:107], v[8:11]
    v_mfma_f32_16x16x32_bf16 v[8:11], v[148:151], v[108:111], v[8:11]
    ds_read_b128 v[152:155], v2 offset:4352
    v_mfma_f32_16x16x32_bf16 v[12:15], v[144:147], v[108:111], v[12:15]
    ds_read_b128 v[156:159], v2 offset:4480
    v_mfma_f32_16x16x32_bf16 v[12:15], v[148:151], v[120:123], v[12:15]
    s_barrier
    v_mfma_f32_16x16x32_bf16 v[16:19], v[144:147], v[120:123], v[16:19]
    ds_read_b64_tr_b16 v[160:161], v1 offset:12288
    v_mfma_f32_16x16x32_bf16 v[16:19], v[148:151], v[124:127], v[16:19]
    ds_read_b64_tr_b16 v[162:163], v1 offset:12800
    v_mfma_f32_16x16x32_bf16 v[20:23], v[144:147], v[124:127], v[20:23]
    ds_read_b64_tr_b16 v[164:165], v1 offset:13312
    v_mfma_f32_16x16x32_bf16 v[20:23], v[148:151], v[136:139], v[20:23]
    ds_read_b64_tr_b16 v[166:167], v1 offset:13824
    v_mfma_f32_16x16x32_bf16 v[24:27], v[144:147], v[136:139], v[24:27]
    v_mfma_f32_16x16x32_bf16 v[24:27], v[148:151], v[140:143], v[24:27]
    v_mfma_f32_16x16x32_bf16 v[28:31], v[144:147], v[140:143], v[28:31]
    s_waitcnt lgkmcnt(2)
    v_mfma_f32_16x16x32_bf16 v[28:31], v[148:151], v[152:155], v[28:31]
    v_mfma_f32_16x16x32_bf16 v[32:35], v[144:147], v[152:155], v[32:35]
    v_mfma_f32_16x16x32_bf16 v[32:35], v[148:151], v[156:159], v[32:35]
    v_mfma_f32_16x16x32_bf16 v[4:7], v[160:163], v[108:111], v[4:7]
    s_waitcnt lgkmcnt(0)
    v_mfma_f32_16x16x32_bf16 v[4:7], v[164:167], v[120:123], v[4:7]
    v_mfma_f32_16x16x32_bf16 v[8:11], v[160:163], v[120:123], v[8:11]
    ds_read_b128 v[168:171], v2 offset:4608
    v_mfma_f32_16x16x32_bf16 v[8:11], v[164:167], v[124:127], v[8:11]
    ds_read_b128 v[172:175], v2 offset:4736
    v_mfma_f32_16x16x32_bf16 v[12:15], v[160:163], v[124:127], v[12:15]
    ds_read_b128 v[176:179], v2 offset:64
    v_mfma_f32_16x16x32_bf16 v[12:15], v[164:167], v[136:139], v[12:15]
    s_barrier
    v_mfma_f32_16x16x32_bf16 v[16:19], v[160:163], v[136:139], v[16:19]
    ds_read_b64_tr_b16 v[180:181], v1 offset:14336
    v_mfma_f32_16x16x32_bf16 v[16:19], v[164:167], v[140:143], v[16:19]
    ds_read_b64_tr_b16 v[182:183], v1 offset:14848
    v_mfma_f32_16x16x32_bf16 v[20:23], v[160:163], v[140:143], v[20:23]
    ds_read_b64_tr_b16 v[184:185], v1 offset:15360
    v_mfma_f32_16x16x32_bf16 v[20:23], v[164:167], v[152:155], v[20:23]
    ds_read_b64_tr_b16 v[186:187], v1 offset:15872
    v_mfma_f32_16x16x32_bf16 v[24:27], v[160:163], v[152:155], v[24:27]
    v_mfma_f32_16x16x32_bf16 v[24:27], v[164:167], v[156:159], v[24:27]
    ds_read_b128 v[188:191], v2 offset:192
    v_mfma_f32_16x16x32_bf16 v[28:31], v[160:163], v[156:159], v[28:31]
    s_waitcnt lgkmcnt(3)
    ds_read_b128 v[192:195], v2 offset:320
    v_mfma_f32_16x16x32_bf16 v[28:31], v[164:167], v[168:171], v[28:31]
    v_mfma_f32_16x16x32_bf16 v[32:35], v[160:163], v[168:171], v[32:35]
    ds_read_b128 v[196:199], v2 offset:448
    v_mfma_f32_16x16x32_bf16 v[32:35], v[164:167], v[172:175], v[32:35]
    ds_read_b128 v[200:203], v2 offset:576
    v_mfma_f32_16x16x32_bf16 v[4:7], v[180:183], v[124:127], v[4:7]
    s_waitcnt lgkmcnt(3)
    ds_read_b128 v[204:207], v2 offset:704
    v_mfma_f32_16x16x32_bf16 v[4:7], v[184:187], v[176:179], v[4:7]
    v_mfma_f32_16x16x32_bf16 v[8:11], v[180:183], v[136:139], v[8:11]
    ds_read_b128 v[208:211], v2 offset:832
    v_mfma_f32_16x16x32_bf16 v[8:11], v[184:187], v[188:191], v[8:11]
    ds_read_b128 v[212:215], v2 offset:4864
    v_mfma_f32_16x16x32_bf16 v[12:15], v[180:183], v[140:143], v[12:15]
    s_waitcnt lgkmcnt(3)
    ds_read_b128 v[216:219], v2 offset:960
    v_mfma_f32_16x16x32_bf16 v[12:15], v[184:187], v[192:195], v[12:15]
    s_barrier
    v_mfma_f32_16x16x32_bf16 v[16:19], v[180:183], v[152:155], v[16:19]
    ds_read_b64_tr_b16 v[220:221], v1 offset:16384
    v_mfma_f32_16x16x32_bf16 v[16:19], v[184:187], v[196:199], v[16:19]
    ds_read_b64_tr_b16 v[222:223], v1 offset:16896
    v_mfma_f32_16x16x32_bf16 v[20:23], v[180:183], v[156:159], v[20:23]
    ds_read_b64_tr_b16 v[224:225], v1 offset:17408
    v_mfma_f32_16x16x32_bf16 v[20:23], v[184:187], v[200:203], v[20:23]
    ds_read_b64_tr_b16 v[226:227], v1 offset:17920
    v_mfma_f32_16x16x32_bf16 v[24:27], v[180:183], v[168:171], v[24:27]
    s_waitcnt lgkmcnt(4)
    v_mfma_f32_16x16x32_bf16 v[24:27], v[184:187], v[204:207], v[24:27]
    v_mfma_f32_16x16x32_bf16 v[28:31], v[180:183], v[172:175], v[28:31]
    v_mfma_f32_16x16x32_bf16 v[28:31], v[184:187], v[208:211], v[28:31]
    v_mfma_f32_16x16x32_bf16 v[32:35], v[180:183], v[212:215], v[32:35]
    v_mfma_f32_16x16x32_bf16 v[32:35], v[184:187], v[216:219], v[32:35]
    s_waitcnt lgkmcnt(0)
    v_mfma_f32_16x16x32_bf16 v[4:7], v[220:223], v[188:191], v[4:7]
    v_mfma_f32_16x16x32_bf16 v[4:7], v[224:227], v[192:195], v[4:7]
    s_barrier
    v_mfma_f32_16x16x32_bf16 v[8:11], v[220:223], v[192:195], v[8:11]
    ds_read_b64_tr_b16 v[228:229], v1 offset:18432
    v_mfma_f32_16x16x32_bf16 v[8:11], v[224:227], v[196:199], v[8:11]
    ds_read_b64_tr_b16 v[230:231], v1 offset:18944
    v_mfma_f32_16x16x32_bf16 v[12:15], v[220:223], v[196:199], v[12:15]
    ds_read_b64_tr_b16 v[232:233], v1 offset:19456
    v_mfma_f32_16x16x32_bf16 v[12:15], v[224:227], v[200:203], v[12:15]
    ds_read_b64_tr_b16 v[234:235], v1 offset:19968
    v_mfma_f32_16x16x32_bf16 v[16:19], v[220:223], v[200:203], v[16:19]
    v_mfma_f32_16x16x32_bf16 v[16:19], v[224:227], v[204:207], v[16:19]
    v_mfma_f32_16x16x32_bf16 v[20:23], v[220:223], v[204:207], v[20:23]
    v_mfma_f32_16x16x32_bf16 v[20:23], v[224:227], v[208:211], v[20:23]
    v_mfma_f32_16x16x32_bf16 v[24:27], v[220:223], v[208:211], v[24:27]
    v_mfma_f32_16x16x32_bf16 v[24:27], v[224:227], v[216:219], v[24:27]
    s_waitcnt lgkmcnt(0)
    ds_read_b128 v[236:239], v2 offset:2176
    v_mfma_f32_16x16x32_bf16 v[4:7], v[228:231], v[196:199], v[4:7]
    ds_read_b128 v[240:243], v2 offset:2304
    v_mfma_f32_16x16x32_bf16 v[4:7], v[232:235], v[200:203], v[4:7]
    s_barrier
    v_mfma_f32_16x16x32_bf16 v[8:11], v[228:231], v[200:203], v[8:11]
    ds_read_b64_tr_b16 v[244:245], v1 offset:20480
    v_mfma_f32_16x16x32_bf16 v[8:11], v[232:235], v[204:207], v[8:11]
    ds_read_b64_tr_b16 v[246:247], v1 offset:20992
    v_mfma_f32_16x16x32_bf16 v[12:15], v[228:231], v[204:207], v[12:15]
    ds_read_b64_tr_b16 v[248:249], v1 offset:21504
L_pad3_1:
    s_cbranch_execz L_pad3_4
    v_mfma_f32_16x16x32_bf16 v[12:15], v[232:235], v[208:211], v[12:15]
    ds_read_b64_tr_b16 v[250:251], v1 offset:22016
    v_mfma_f32_16x16x32_bf16 v[16:19], v[228:231], v[208:211], v[16:19]
    v_mfma_f32_16x16x32_bf16 v[16:19], v[232:235], v[216:219], v[16:19]
    v_mfma_f32_16x16x32_bf16 v[20:23], v[228:231], v[216:219], v[20:23]
    s_waitcnt lgkmcnt(2)
    v_mfma_f32_16x16x32_bf16 v[20:23], v[232:235], v[236:239], v[20:23]
    v_mfma_f32_16x16x32_bf16 v[24:27], v[228:231], v[236:239], v[24:27]
    v_mfma_f32_16x16x32_bf16 v[24:27], v[232:235], v[240:243], v[24:27]
    ds_read_b128 v[252:255], v2 offset:2432
    v_mfma_f32_16x16x32_bf16 v[4:7], v[244:247], v[204:207], v[4:7]
    s_waitcnt lgkmcnt(1)
    ds_read_b128 v[40:43], v2 offset:2560
    v_mfma_f32_16x16x32_bf16 v[4:7], v[248:251], v[208:211], v[4:7]
    s_barrier
    v_mfma_f32_16x16x32_bf16 v[8:11], v[244:247], v[208:211], v[8:11]
    ds_read_b64_tr_b16 v[36:37], v1 offset:22528
    v_mfma_f32_16x16x32_bf16 v[8:11], v[248:251], v[216:219], v[8:11]
    ds_read_b64_tr_b16 v[38:39], v1 offset:23040
    v_mfma_f32_16x16x32_bf16 v[12:15], v[244:247], v[216:219], v[12:15]
    ds_read_b64_tr_b16 v[44:45], v1 offset:23552
    v_mfma_f32_16x16x32_bf16 v[12:15], v[248:251], v[236:239], v[12:15]
    ds_read_b64_tr_b16 v[46:47], v1 offset:24064
    v_mfma_f32_16x16x32_bf16 v[16:19], v[244:247], v[236:239], v[16:19]
    v_mfma_f32_16x16x32_bf16 v[16:19], v[248:251], v[240:243], v[16:19]
    v_mfma_f32_16x16x32_bf16 v[20:23], v[244:247], v[240:243], v[20:23]
    s_waitcnt lgkmcnt(2)
    v_mfma_f32_16x16x32_bf16 v[20:23], v[248:251], v[252:255], v[20:23]
    v_mfma_f32_16x16x32_bf16 v[24:27], v[244:247], v[252:255], v[24:27]
    v_mfma_f32_16x16x32_bf16 v[24:27], v[248:251], v[40:43], v[24:27]
    ds_read_b128 v[72:75], v2 offset:2688
    v_mfma_f32_16x16x32_bf16 v[4:7], v[36:39], v[216:219], v[4:7]
    s_waitcnt lgkmcnt(1)
    ds_read_b128 v[48:51], v2 offset:2816
    v_mfma_f32_16x16x32_bf16 v[4:7], v[44:47], v[236:239], v[4:7]
    s_barrier
    v_mfma_f32_16x16x32_bf16 v[8:11], v[36:39], v[236:239], v[8:11]
    ds_read_b64_tr_b16 v[80:81], v1 offset:0
    v_mfma_f32_16x16x32_bf16 v[8:11], v[44:47], v[240:243], v[8:11]
    ds_read_b64_tr_b16 v[82:83], v1 offset:512
    v_mfma_f32_16x16x32_bf16 v[12:15], v[36:39], v[240:243], v[12:15]
    ds_read_b64_tr_b16 v[52:53], v1 offset:1024
    v_mfma_f32_16x16x32_bf16 v[12:15], v[44:47], v[252:255], v[12:15]
    ds_read_b64_tr_b16 v[54:55], v1 offset:1536
    v_mfma_f32_16x16x32_bf16 v[16:19], v[36:39], v[252:255], v[16:19]
    v_mfma_f32_16x16x32_bf16 v[16:19], v[44:47], v[40:43], v[16:19]
    v_mfma_f32_16x16x32_bf16 v[20:23], v[36:39], v[40:43], v[20:23]
    s_waitcnt lgkmcnt(2)
    v_mfma_f32_16x16x32_bf16 v[20:23], v[44:47], v[72:75], v[20:23]
    v_mfma_f32_16x16x32_bf16 v[24:27], v[36:39], v[72:75], v[24:27]
    v_mfma_f32_16x16x32_bf16 v[24:27], v[44:47], v[48:51], v[24:27]
    ds_read_b128 v[88:91], v2 offset:2944
    v_mfma_f32_16x16x32_bf16 v[4:7], v[80:83], v[240:243], v[4:7]
    s_waitcnt lgkmcnt(1)
    ds_read_b128 v[56:59], v2 offset:3072
    v_mfma_f32_16x16x32_bf16 v[4:7], v[52:55], v[252:255], v[4:7]
    s_barrier
    v_mfma_f32_16x16x32_bf16 v[8:11], v[80:83], v[252:255], v[8:11]
    ds_read_b64_tr_b16 v[60:61], v1 offset:2048
    v_mfma_f32_16x16x32_bf16 v[8:11], v[52:55], v[40:43], v[8:11]
    ds_read_b64_tr_b16 v[62:63], v1 offset:2560
    v_mfma_f32_16x16x32_bf16 v[12:15], v[80:83], v[40:43], v[12:15]
    ds_read_b64_tr_b16 v[96:97], v1 offset:3072
    v_mfma_f32_16x16x32_bf16 v[12:15], v[52:55], v[72:75], v[12:15]
    ds_read_b64_tr_b16 v[98:99], v1 offset:3584
    v_mfma_f32_16x16x32_bf16 v[16:19], v[80:83], v[72:75], v[16:19]
    v_mfma_f32_16x16x32_bf16 v[16:19], v[52:55], v[48:51], v[16:19]
    v_mfma_f32_16x16x32_bf16 v[20:23], v[80:83], v[48:51], v[20:23]
    s_waitcnt lgkmcnt(2)
    v_mfma_f32_16x16x32_bf16 v[20:23], v[52:55], v[88:91], v[20:23]
    v_mfma_f32_16x16x32_bf16 v[24:27], v[80:83], v[88:91], v[24:27]
    v_mfma_f32_16x16x32_bf16 v[24:27], v[52:55], v[56:59], v[24:27]
    ds_read_b128 v[100:103], v2 offset:4288
    v_mfma_f32_16x16x32_bf16 v[4:7], v[60:63], v[40:43], v[4:7]
    s_waitcnt lgkmcnt(1)
    ds_read_b128 v[64:67], v2 offset:4416
    v_mfma_f32_16x16x32_bf16 v[4:7], v[96:99], v[72:75], v[4:7]
    s_barrier
    v_mfma_f32_16x16x32_bf16 v[8:11], v[60:63], v[72:75], v[8:11]
    ds_read_b64_tr_b16 v[68:69], v1 offset:4096
    v_mfma_f32_16x16x32_bf16 v[8:11], v[96:99], v[48:51], v[8:11]
    ds_read_b64_tr_b16 v[70:71], v1 offset:4608
    v_mfma_f32_16x16x32_bf16 v[12:15], v[60:63], v[48:51], v[12:15]
    ds_read_b64_tr_b16 v[112:113], v1 offset:5120
    v_mfma_f32_16x16x32_bf16 v[12:15], v[96:99], v[88:91], v[12:15]
    ds_read_b64_tr_b16 v[114:115], v1 offset:5632
    v_mfma_f32_16x16x32_bf16 v[16:19], v[60:63], v[88:91], v[16:19]
    v_mfma_f32_16x16x32_bf16 v[16:19], v[96:99], v[56:59], v[16:19]
    v_mfma_f32_16x16x32_bf16 v[20:23], v[60:63], v[56:59], v[20:23]
    s_waitcnt lgkmcnt(2)
    ds_read_b128 v[116:119], v2 offset:4544
    v_mfma_f32_16x16x32_bf16 v[20:23], v[96:99], v[100:103], v[20:23]
    v_mfma_f32_16x16x32_bf16 v[24:27], v[60:63], v[100:103], v[24:27]
    ds_read_b128 v[76:79], v2 offset:4672
    v_mfma_f32_16x16x32_bf16 v[24:27], v[96:99], v[64:67], v[24:27]
    ds_read_b128 v[84:87], v2 offset:21120
    v_mfma_f32_16x16x32_bf16 v[4:7], v[68:71], v[48:51], v[4:7]
    s_waitcnt lgkmcnt(3)
    ds_read_b128 v[128:131], v2 offset:21248
    v_mfma_f32_16x16x32_bf16 v[4:7], v[112:115], v[88:91], v[4:7]
    s_barrier
    v_mfma_f32_16x16x32_bf16 v[8:11], v[68:71], v[88:91], v[8:11]
    ds_read_b64_tr_b16 v[132:133], v1 offset:6144
    v_mfma_f32_16x16x32_bf16 v[8:11], v[112:115], v[56:59], v[8:11]
    ds_read_b64_tr_b16 v[134:135], v1 offset:6656
    v_mfma_f32_16x16x32_bf16 v[12:15], v[68:71], v[56:59], v[12:15]
    ds_read_b64_tr_b16 v[92:93], v1 offset:7168
    v_mfma_f32_16x16x32_bf16 v[12:15], v[112:115], v[100:103], v[12:15]
    ds_read_b64_tr_b16 v[94:95], v1 offset:7680
    v_mfma_f32_16x16x32_bf16 v[16:19], v[68:71], v[100:103], v[16:19]
    v_mfma_f32_16x16x32_bf16 v[16:19], v[112:115], v[64:67], v[16:19]
    ds_read_b128 v[104:107], v2 offset:21376
    v_mfma_f32_16x16x32_bf16 v[20:23], v[68:71], v[64:67], v[20:23]
    s_waitcnt lgkmcnt(3)
    ds_read_b128 v[144:147], v2 offset:21504
    v_mfma_f32_16x16x32_bf16 v[20:23], v[112:115], v[116:119], v[20:23]
    v_mfma_f32_16x16x32_bf16 v[24:27], v[68:71], v[116:119], v[24:27]
    ds_read_b128 v[148:151], v2 offset:21632
    v_mfma_f32_16x16x32_bf16 v[24:27], v[112:115], v[76:79], v[24:27]
    ds_read_b128 v[108:111], v2 offset:21760
    v_mfma_f32_16x16x32_bf16 v[4:7], v[132:135], v[84:87], v[4:7]
    s_waitcnt lgkmcnt(3)
    ds_read_b128 v[120:123], v2 offset:21888
    v_mfma_f32_16x16x32_bf16 v[4:7], v[92:95], v[128:131], v[4:7]
    s_barrier
    v_mfma_f32_16x16x32_bf16 v[8:11], v[132:135], v[128:131], v[8:11]
    ds_read_b64_tr_b16 v[160:161], v1 offset:8192
    v_mfma_f32_16x16x32_bf16 v[8:11], v[92:95], v[104:107], v[8:11]
    ds_read_b64_tr_b16 v[162:163], v1 offset:8704
    v_mfma_f32_16x16x32_bf16 v[12:15], v[132:135], v[104:107], v[12:15]
    s_waitcnt lgkmcnt(3)
    ds_read_b64_tr_b16 v[164:165], v1 offset:9216
    v_mfma_f32_16x16x32_bf16 v[12:15], v[92:95], v[144:147], v[12:15]
    ds_read_b64_tr_b16 v[166:167], v1 offset:9728
    v_mfma_f32_16x16x32_bf16 v[16:19], v[132:135], v[144:147], v[16:19]
L_pad3_2:
    s_cbranch_execz L_pad3_5
    v_mfma_f32_16x16x32_bf16 v[16:19], v[92:95], v[148:151], v[16:19]
    v_mfma_f32_16x16x32_bf16 v[20:23], v[132:135], v[148:151], v[20:23]
    v_mfma_f32_16x16x32_bf16 v[20:23], v[92:95], v[108:111], v[20:23]
    v_mfma_f32_16x16x32_bf16 v[24:27], v[132:135], v[108:111], v[24:27]
    s_waitcnt lgkmcnt(0)
    v_mfma_f32_16x16x32_bf16 v[24:27], v[92:95], v[120:123], v[24:27]
    ds_read_b128 v[124:127], v2 offset:22016
    v_mfma_f32_16x16x32_bf16 v[4:7], v[160:163], v[104:107], v[4:7]
    ds_read_b128 v[176:179], v2 offset:23232
    v_mfma_f32_16x16x32_bf16 v[4:7], v[164:167], v[144:147], v[4:7]
    s_barrier
    v_mfma_f32_16x16x32_bf16 v[8:11], v[160:163], v[144:147], v[8:11]
    ds_read_b64_tr_b16 v[136:137], v1 offset:10240
    v_mfma_f32_16x16x32_bf16 v[8:11], v[164:167], v[148:151], v[8:11]
    ds_read_b64_tr_b16 v[138:139], v1 offset:10752
    v_mfma_f32_16x16x32_bf16 v[12:15], v[160:163], v[148:151], v[12:15]
    ds_read_b64_tr_b16 v[140:141], v1 offset:11264
    v_mfma_f32_16x16x32_bf16 v[12:15], v[164:167], v[108:111], v[12:15]
    ds_read_b64_tr_b16 v[142:143], v1 offset:11776
    v_mfma_f32_16x16x32_bf16 v[16:19], v[160:163], v[108:111], v[16:19]
    v_mfma_f32_16x16x32_bf16 v[16:19], v[164:167], v[120:123], v[16:19]
    v_mfma_f32_16x16x32_bf16 v[20:23], v[160:163], v[120:123], v[20:23]
    s_waitcnt lgkmcnt(2)
    v_mfma_f32_16x16x32_bf16 v[20:23], v[164:167], v[124:127], v[20:23]
    v_mfma_f32_16x16x32_bf16 v[24:27], v[160:163], v[124:127], v[24:27]
    v_mfma_f32_16x16x32_bf16 v[24:27], v[164:167], v[176:179], v[24:27]
    ds_read_b128 v[152:155], v2 offset:23360
    v_mfma_f32_16x16x32_bf16 v[4:7], v[136:139], v[148:151], v[4:7]
    s_waitcnt lgkmcnt(1)
    ds_read_b128 v[156:159], v2 offset:23488
    v_mfma_f32_16x16x32_bf16 v[4:7], v[140:143], v[108:111], v[4:7]
    s_barrier
    v_mfma_f32_16x16x32_bf16 v[8:11], v[136:139], v[108:111], v[8:11]
    ds_read_b64_tr_b16 v[168:169], v1 offset:12288
    v_mfma_f32_16x16x32_bf16 v[8:11], v[140:143], v[120:123], v[8:11]
    ds_read_b64_tr_b16 v[170:171], v1 offset:12800
    v_mfma_f32_16x16x32_bf16 v[12:15], v[136:139], v[120:123], v[12:15]
    ds_read_b64_tr_b16 v[172:173], v1 offset:13312
    v_mfma_f32_16x16x32_bf16 v[12:15], v[140:143], v[124:127], v[12:15]
    ds_read_b64_tr_b16 v[174:175], v1 offset:13824
    v_mfma_f32_16x16x32_bf16 v[16:19], v[136:139], v[124:127], v[16:19]
    v_mfma_f32_16x16x32_bf16 v[16:19], v[140:143], v[176:179], v[16:19]
    v_mfma_f32_16x16x32_bf16 v[20:23], v[136:139], v[176:179], v[20:23]
    s_waitcnt lgkmcnt(2)
    v_mfma_f32_16x16x32_bf16 v[20:23], v[140:143], v[152:155], v[20:23]
    v_mfma_f32_16x16x32_bf16 v[24:27], v[136:139], v[152:155], v[24:27]
    v_mfma_f32_16x16x32_bf16 v[24:27], v[140:143], v[156:159], v[24:27]
    ds_read_b128 v[180:183], v2 offset:23616
    v_mfma_f32_16x16x32_bf16 v[4:7], v[168:171], v[120:123], v[4:7]
    s_waitcnt lgkmcnt(1)
    ds_read_b128 v[212:215], v2 offset:23744
    v_mfma_f32_16x16x32_bf16 v[4:7], v[172:175], v[124:127], v[4:7]
    s_barrier
    v_mfma_f32_16x16x32_bf16 v[8:11], v[168:171], v[124:127], v[8:11]
    ds_read_b64_tr_b16 v[184:185], v1 offset:14336
    v_mfma_f32_16x16x32_bf16 v[8:11], v[172:175], v[176:179], v[8:11]
    ds_read_b64_tr_b16 v[186:187], v1 offset:14848
    v_mfma_f32_16x16x32_bf16 v[12:15], v[168:171], v[176:179], v[12:15]
    ds_read_b64_tr_b16 v[188:189], v1 offset:15360
    v_mfma_f32_16x16x32_bf16 v[12:15], v[172:175], v[152:155], v[12:15]
    ds_read_b64_tr_b16 v[190:191], v1 offset:15872
    v_mfma_f32_16x16x32_bf16 v[16:19], v[168:171], v[152:155], v[16:19]
    v_mfma_f32_16x16x32_bf16 v[16:19], v[172:175], v[156:159], v[16:19]
    v_mfma_f32_16x16x32_bf16 v[20:23], v[168:171], v[156:159], v[20:23]
    s_waitcnt lgkmcnt(2)
    v_mfma_f32_16x16x32_bf16 v[20:23], v[172:175], v[180:183], v[20:23]
    v_mfma_f32_16x16x32_bf16 v[24:27], v[168:171], v[180:183], v[24:27]
    v_mfma_f32_16x16x32_bf16 v[24:27], v[172:175], v[212:215], v[24:27]
    ds_read_b128 v[192:195], v2 offset:23872
    v_mfma_f32_16x16x32_bf16 v[4:7], v[184:187], v[176:179], v[4:7]
    s_waitcnt lgkmcnt(1)
    ds_read_b128 v[196:199], v2 offset:24000
    v_mfma_f32_16x16x32_bf16 v[4:7], v[188:191], v[152:155], v[4:7]
    s_barrier
    v_mfma_f32_16x16x32_bf16 v[8:11], v[184:187], v[152:155], v[8:11]
    ds_read_b64_tr_b16 v[200:201], v1 offset:16384
    v_mfma_f32_16x16x32_bf16 v[8:11], v[188:191], v[156:159], v[8:11]
    ds_read_b64_tr_b16 v[202:203], v1 offset:16896
    v_mfma_f32_16x16x32_bf16 v[12:15], v[184:187], v[156:159], v[12:15]
    ds_read_b64_tr_b16 v[204:205], v1 offset:17408
    v_mfma_f32_16x16x32_bf16 v[12:15], v[188:191], v[180:183], v[12:15]
    ds_read_b64_tr_b16 v[206:207], v1 offset:17920
    v_mfma_f32_16x16x32_bf16 v[16:19], v[184:187], v[180:183], v[16:19]
    v_mfma_f32_16x16x32_bf16 v[16:19], v[188:191], v[212:215], v[16:19]
    v_mfma_f32_16x16x32_bf16 v[20:23], v[184:187], v[212:215], v[20:23]
    s_waitcnt lgkmcnt(2)
    ds_read_b128 v[208:211], v2 offset:24128
    v_mfma_f32_16x16x32_bf16 v[20:23], v[188:191], v[192:195], v[20:23]
    v_mfma_f32_16x16x32_bf16 v[24:27], v[184:187], v[192:195], v[24:27]
    ds_read_b128 v[216:219], v2 offset:25344
    v_mfma_f32_16x16x32_bf16 v[24:27], v[188:191], v[196:199], v[24:27]
    ds_read_b128 v[236:239], v2 offset:25472
    v_mfma_f32_16x16x32_bf16 v[4:7], v[200:203], v[156:159], v[4:7]
    s_waitcnt lgkmcnt(3)
    ds_read_b128 v[240:243], v2 offset:25600
    v_mfma_f32_16x16x32_bf16 v[4:7], v[204:207], v[180:183], v[4:7]
    s_barrier
    v_mfma_f32_16x16x32_bf16 v[8:11], v[200:203], v[180:183], v[8:11]
    ds_read_b64_tr_b16 v[252:253], v1 offset:18432
    v_mfma_f32_16x16x32_bf16 v[8:11], v[204:207], v[212:215], v[8:11]
    ds_read_b64_tr_b16 v[254:255], v1 offset:18944
    v_mfma_f32_16x16x32_bf16 v[12:15], v[200:203], v[212:215], v[12:15]
    ds_read_b64_tr_b16 v[40:41], v1 offset:19456
    v_mfma_f32_16x16x32_bf16 v[12:15], v[204:207], v[192:195], v[12:15]
    ds_read_b64_tr_b16 v[42:43], v1 offset:19968
    v_mfma_f32_16x16x32_bf16 v[16:19], v[200:203], v[192:195], v[16:19]
    v_mfma_f32_16x16x32_bf16 v[16:19], v[204:207], v[196:199], v[16:19]
    ds_read_b128 v[72:75], v2 offset:21184
    v_mfma_f32_16x16x32_bf16 v[20:23], v[200:203], v[196:199], v[20:23]
    s_waitcnt lgkmcnt(3)
    ds_read_b128 v[48:51], v2 offset:21312
    v_mfma_f32_16x16x32_bf16 v[20:23], v[204:207], v[208:211], v[20:23]
    v_mfma_f32_16x16x32_bf16 v[24:27], v[200:203], v[208:211], v[24:27]
    ds_read_b128 v[88:91], v2 offset:21696
    v_mfma_f32_16x16x32_bf16 v[24:27], v[204:207], v[216:219], v[24:27]
    ds_read_b128 v[56:59], v2 offset:25728
    v_mfma_f32_16x16x32_bf16 v[4:7], v[252:255], v[212:215], v[4:7]
    s_waitcnt lgkmcnt(3)
    ds_read_b128 v[100:103], v2 offset:21824
    v_mfma_f32_16x16x32_bf16 v[4:7], v[40:43], v[192:195], v[4:7]
    s_barrier
    v_mfma_f32_16x16x32_bf16 v[8:11], v[252:255], v[192:195], v[8:11]
    ds_read_b64_tr_b16 v[64:65], v1 offset:20480
    v_mfma_f32_16x16x32_bf16 v[8:11], v[40:43], v[196:199], v[8:11]
    ds_read_b64_tr_b16 v[66:67], v1 offset:20992
    v_mfma_f32_16x16x32_bf16 v[12:15], v[252:255], v[196:199], v[12:15]
    ds_read_b64_tr_b16 v[116:117], v1 offset:21504
    v_mfma_f32_16x16x32_bf16 v[12:15], v[40:43], v[208:211], v[12:15]
    ds_read_b64_tr_b16 v[118:119], v1 offset:22016
    v_mfma_f32_16x16x32_bf16 v[16:19], v[252:255], v[208:211], v[16:19]
    v_mfma_f32_16x16x32_bf16 v[16:19], v[40:43], v[216:219], v[16:19]
    ds_read_b128 v[76:79], v2 offset:21440
    v_mfma_f32_16x16x32_bf16 v[20:23], v[252:255], v[216:219], v[20:23]
    ds_read_b128 v[84:87], v2 offset:21568
    v_mfma_f32_16x16x32_bf16 v[20:23], v[40:43], v[236:239], v[20:23]
    s_barrier
    v_mfma_f32_16x16x32_bf16 v[24:27], v[252:255], v[236:239], v[24:27]
    ds_read_b64_tr_b16 v[128:129], v1 offset:22528
L_pad3_3:
    s_cbranch_execz L_main3
    v_mfma_f32_16x16x32_bf16 v[24:27], v[40:43], v[240:243], v[24:27]
    s_waitcnt lgkmcnt(3)
    ds_read_b64_tr_b16 v[130:131], v1 offset:23040
    v_mfma_f32_16x16x32_bf16 v[4:7], v[64:67], v[196:199], v[4:7]
    ds_read_b64_tr_b16 v[104:105], v1 offset:23552
    v_mfma_f32_16x16x32_bf16 v[4:7], v[116:119], v[72:75], v[4:7]
    ds_read_b64_tr_b16 v[106:107], v1 offset:24064
    v_mfma_f32_16x16x32_bf16 v[8:11], v[64:67], v[208:211], v[8:11]
    v_mfma_f32_16x16x32_bf16 v[8:11], v[116:119], v[48:51], v[8:11]
    ds_read_b128 v[144:147], v2 offset:21952
    v_mfma_f32_16x16x32_bf16 v[20:23], v[64:67], v[240:243], v[20:23]
    ds_read_b128 v[148:151], v2 offset:22080
    v_mfma_f32_16x16x32_bf16 v[20:23], v[116:119], v[88:91], v[20:23]
    s_barrier
    v_mfma_f32_16x16x32_bf16 v[24:27], v[64:67], v[56:59], v[24:27]
    ds_read_b64_tr_b16 v[108:109], v1 offset:0
    v_mfma_f32_16x16x32_bf16 v[24:27], v[116:119], v[100:103], v[24:27]
    s_waitcnt lgkmcnt(3)
    ds_read_b64_tr_b16 v[110:111], v1 offset:512
    v_mfma_f32_16x16x32_bf16 v[4:7], v[128:131], v[48:51], v[4:7]
    ds_read_b64_tr_b16 v[120:121], v1 offset:1024
    v_mfma_f32_16x16x32_bf16 v[4:7], v[104:107], v[76:79], v[4:7]
    ds_read_b64_tr_b16 v[122:123], v1 offset:1536
    v_mfma_f32_16x16x32_bf16 v[8:11], v[128:131], v[76:79], v[8:11]
    v_mfma_f32_16x16x32_bf16 v[8:11], v[104:107], v[84:87], v[8:11]
    ds_read_b128 v[124:127], v2 offset:23296
    v_mfma_f32_16x16x32_bf16 v[20:23], v[128:131], v[100:103], v[20:23]
    s_waitcnt lgkmcnt(3)
    ds_read_b128 v[176:179], v2 offset:23424
    v_mfma_f32_16x16x32_bf16 v[20:23], v[104:107], v[144:147], v[20:23]
    s_barrier
    v_mfma_f32_16x16x32_bf16 v[24:27], v[128:131], v[144:147], v[24:27]
    ds_read_b64_tr_b16 v[152:153], v1 offset:2048
    v_mfma_f32_16x16x32_bf16 v[24:27], v[104:107], v[148:151], v[24:27]
    ds_read_b64_tr_b16 v[154:155], v1 offset:2560
    v_mfma_f32_16x16x32_bf16 v[4:7], v[108:111], v[84:87], v[4:7]
    s_waitcnt lgkmcnt(3)
    ds_read_b64_tr_b16 v[156:157], v1 offset:3072
    v_mfma_f32_16x16x32_bf16 v[4:7], v[120:123], v[88:91], v[4:7]
    ds_read_b64_tr_b16 v[158:159], v1 offset:3584
    v_mfma_f32_16x16x32_bf16 v[8:11], v[108:111], v[88:91], v[8:11]
    v_mfma_f32_16x16x32_bf16 v[8:11], v[120:123], v[100:103], v[8:11]
    ds_read_b128 v[180:183], v2 offset:23552
    v_mfma_f32_16x16x32_bf16 v[20:23], v[108:111], v[148:151], v[20:23]
    ds_read_b128 v[212:215], v2 offset:23680
    v_mfma_f32_16x16x32_bf16 v[20:23], v[120:123], v[124:127], v[20:23]
    s_barrier
    v_mfma_f32_16x16x32_bf16 v[24:27], v[108:111], v[124:127], v[24:27]
    s_waitcnt lgkmcnt(2)
    ds_read_b64_tr_b16 v[192:193], v1 offset:4096
    v_mfma_f32_16x16x32_bf16 v[24:27], v[120:123], v[176:179], v[24:27]
    ds_read_b64_tr_b16 v[194:195], v1 offset:4608
    v_mfma_f32_16x16x32_bf16 v[4:7], v[152:155], v[100:103], v[4:7]
    ds_read_b64_tr_b16 v[216:217], v1 offset:5120
    v_mfma_f32_16x16x32_bf16 v[4:7], v[156:159], v[144:147], v[4:7]
    ds_read_b64_tr_b16 v[218:219], v1 offset:5632
    v_mfma_f32_16x16x32_bf16 v[8:11], v[152:155], v[144:147], v[8:11]
    v_mfma_f32_16x16x32_bf16 v[8:11], v[156:159], v[148:151], v[8:11]
    ds_read_b128 v[236:239], v2 offset:23808
    v_mfma_f32_16x16x32_bf16 v[20:23], v[152:155], v[176:179], v[20:23]
    s_waitcnt lgkmcnt(3)
    ds_read_b128 v[196:199], v2 offset:23936
    v_mfma_f32_16x16x32_bf16 v[20:23], v[156:159], v[180:183], v[20:23]
    s_barrier
    v_mfma_f32_16x16x32_bf16 v[24:27], v[152:155], v[180:183], v[24:27]
    ds_read_b64_tr_b16 v[72:73], v1 offset:6144
    v_mfma_f32_16x16x32_bf16 v[24:27], v[156:159], v[212:215], v[24:27]
    ds_read_b64_tr_b16 v[74:75], v1 offset:6656
    v_mfma_f32_16x16x32_bf16 v[4:7], v[192:195], v[148:151], v[4:7]
    s_waitcnt lgkmcnt(3)
    ds_read_b64_tr_b16 v[208:209], v1 offset:7168
    v_mfma_f32_16x16x32_bf16 v[4:7], v[216:219], v[124:127], v[4:7]
    ds_read_b64_tr_b16 v[210:211], v1 offset:7680
    v_mfma_f32_16x16x32_bf16 v[8:11], v[192:195], v[124:127], v[8:11]
    v_mfma_f32_16x16x32_bf16 v[8:11], v[216:219], v[176:179], v[8:11]
    ds_read_b128 v[240:243], v2 offset:24064
    v_mfma_f32_16x16x32_bf16 v[20:23], v[192:195], v[212:215], v[20:23]
    ds_read_b128 v[56:59], v2 offset:24192
    v_mfma_f32_16x16x32_bf16 v[20:23], v[216:219], v[236:239], v[20:23]
    s_barrier
    v_mfma_f32_16x16x32_bf16 v[24:27], v[192:195], v[236:239], v[24:27]
    s_waitcnt lgkmcnt(2)
    ds_read_b64_tr_b16 v[48:49], v1 offset:8192
    v_mfma_f32_16x16x32_bf16 v[24:27], v[216:219], v[196:199], v[24:27]
    ds_read_b64_tr_b16 v[50:51], v1 offset:8704
    v_mfma_f32_16x16x32_bf16 v[4:7], v[72:75], v[176:179], v[4:7]
    ds_read_b64_tr_b16 v[76:77], v1 offset:9216
    v_mfma_f32_16x16x32_bf16 v[4:7], v[208:211], v[180:183], v[4:7]
    ds_read_b64_tr_b16 v[78:79], v1 offset:9728
    v_mfma_f32_16x16x32_bf16 v[8:11], v[72:75], v[180:183], v[8:11]
    v_mfma_f32_16x16x32_bf16 v[8:11], v[208:211], v[212:215], v[8:11]
    ds_read_b128 v[84:87], v2 offset:25408
    v_mfma_f32_16x16x32_bf16 v[20:23], v[72:75], v[196:199], v[20:23]
    s_waitcnt lgkmcnt(3)
    ds_read_b128 v[88:91], v2 offset:25536
    v_mfma_f32_16x16x32_bf16 v[20:23], v[208:211], v[240:243], v[20:23]
    s_barrier
    v_mfma_f32_16x16x32_bf16 v[24:27], v[72:75], v[240:243], v[24:27]
    ds_read_b64_tr_b16 v[100:101], v1 offset:10240
    v_mfma_f32_16x16x32_bf16 v[24:27], v[208:211], v[56:59], v[24:27]
    ds_read_b64_tr_b16 v[102:103], v1 offset:10752
    v_mfma_f32_16x16x32_bf16 v[4:7], v[48:51], v[212:215], v[4:7]
    s_waitcnt lgkmcnt(3)
    ds_read_b64_tr_b16 v[144:145], v1 offset:11264
    v_mfma_f32_16x16x32_bf16 v[4:7], v[76:79], v[236:239], v[4:7]
    ds_read_b64_tr_b16 v[146:147], v1 offset:11776
    v_mfma_f32_16x16x32_bf16 v[8:11], v[48:51], v[236:239], v[8:11]
    v_mfma_f32_16x16x32_bf16 v[8:11], v[76:79], v[196:199], v[8:11]
    v_mfma_f32_16x16x32_bf16 v[20:23], v[48:51], v[56:59], v[20:23]
    v_mfma_f32_16x16x32_bf16 v[20:23], v[76:79], v[84:87], v[20:23]
    ds_read_b128 v[148:151], v2 offset:25664
    v_mfma_f32_16x16x32_bf16 v[24:27], v[48:51], v[84:87], v[24:27]
    s_waitcnt lgkmcnt(1)
    ds_read_b128 v[124:127], v2 offset:25792
    v_mfma_f32_16x16x32_bf16 v[24:27], v[76:79], v[88:91], v[24:27]
    ds_read_b128 v[176:179], v2 offset:25344
    v_mfma_f32_16x16x32_bf16 v[4:7], v[100:103], v[196:199], v[4:7]
    v_mfma_f32_16x16x32_bf16 v[4:7], v[144:147], v[240:243], v[4:7]
    ds_read_b128 v[180:183], v2 offset:25472
    v_mfma_f32_16x16x32_bf16 v[8:11], v[100:103], v[240:243], v[8:11]
    ds_read_b128 v[212:215], v2 offset:21440
    v_mfma_f32_16x16x32_bf16 v[8:11], v[144:147], v[56:59], v[8:11]
    s_nop 0
    ds_read_b128 v[236:239], v2 offset:21568
    s_nop 0
    v_mfma_f32_16x16x32_bf16 v[20:23], v[100:103], v[88:91], v[20:23]
    s_waitcnt lgkmcnt(3)
    s_nop 1
    v_mfma_f32_16x16x32_bf16 v[20:23], v[144:147], v[148:151], v[20:23]
    ds_read_b128 v[84:87], v2 offset:21696
    v_cvt_pk_bf16_f32 v4, v4, v5
    v_mfma_f32_16x16x32_bf16 v[24:27], v[100:103], v[148:151], v[24:27]
    v_cvt_pk_bf16_f32 v5, v6, v7
    v_cvt_pk_bf16_f32 v6, v8, v9
    v_mfma_f32_16x16x32_bf16 v[24:27], v[144:147], v[124:127], v[24:27]
    ds_read_b128 v[196:199], v2 offset:21824
    v_cvt_pk_bf16_f32 v7, v10, v11
    v_mfma_f32_16x16x32_bf16 v[12:15], v[64:67], v[176:179], v[12:15]
    s_waitcnt lgkmcnt(2)
    v_min_u32 v4, -2, v4
    v_min_u32 v5, -2, v5
    v_mfma_f32_16x16x32_bf16 v[16:19], v[64:67], v[180:183], v[16:19]
    ds_read_b128 v[240:243], v2 offset:21952
    v_min_u32 v6, -2, v6
    v_mfma_f32_16x16x32_bf16 v[12:15], v[116:119], v[212:215], v[12:15]
    v_min_u32 v7, -2, v7
    v_mfma_f32_16x16x32_bf16 v[12:15], v[128:131], v[236:239], v[12:15]
    buffer_store_dwordx4 v[4:7], v3, s[28:31], s40 offen sc1
    ds_read_b128 v[56:59], v2 offset:22080
L_pad3_4:
    s_cbranch_execz L_main3
    v_cvt_pk_bf16_f32 v20, v20, v21
    v_cvt_pk_bf16_f32 v21, v22, v23
    v_cvt_pk_bf16_f32 v22, v24, v25
    v_mfma_f32_16x16x32_bf16 v[16:19], v[116:119], v[236:239], v[16:19]
    s_waitcnt lgkmcnt(2)
    v_cvt_pk_bf16_f32 v23, v26, v27
    v_min_u32 v20, -2, v20
    v_mfma_f32_16x16x32_bf16 v[16:19], v[128:131], v[84:87], v[16:19]
    ds_read_b128 v[88:91], v2 offset:23296
    v_min_u32 v21, -2, v21
    v_mfma_f32_16x16x32_bf16 v[12:15], v[104:107], v[84:87], v[12:15]
    v_min_u32 v22, -2, v22
    v_min_u32 v23, -2, v23
    v_mfma_f32_16x16x32_bf16 v[12:15], v[108:111], v[196:199], v[12:15]
    buffer_store_dwordx4 v[20:23], v3, s[28:31], s42 offen sc1
    ds_read_b128 v[148:151], v2 offset:23424
    v_mfma_f32_16x16x32_bf16 v[16:19], v[104:107], v[196:199], v[16:19]
    s_waitcnt lgkmcnt(2)
    v_mfma_f32_16x16x32_bf16 v[16:19], v[108:111], v[240:243], v[16:19]
    ds_read_b128 v[124:127], v2 offset:23552
    v_mfma_f32_16x16x32_bf16 v[12:15], v[120:123], v[240:243], v[12:15]
    v_mfma_f32_16x16x32_bf16 v[12:15], v[152:155], v[56:59], v[12:15]
    ds_read_b128 v[176:179], v2 offset:23680
    v_mfma_f32_16x16x32_bf16 v[16:19], v[120:123], v[56:59], v[16:19]
    s_waitcnt lgkmcnt(2)
    v_mfma_f32_16x16x32_bf16 v[16:19], v[152:155], v[88:91], v[16:19]
    ds_read_b128 v[180:183], v2 offset:23808
    v_mfma_f32_16x16x32_bf16 v[12:15], v[156:159], v[88:91], v[12:15]
    v_mfma_f32_16x16x32_bf16 v[12:15], v[192:195], v[148:151], v[12:15]
    ds_read_b128 v[212:215], v2 offset:23936
    v_mfma_f32_16x16x32_bf16 v[16:19], v[156:159], v[148:151], v[16:19]
    s_waitcnt lgkmcnt(2)
    v_mfma_f32_16x16x32_bf16 v[16:19], v[192:195], v[124:127], v[16:19]
    ds_read_b128 v[236:239], v2 offset:24064
    v_mfma_f32_16x16x32_bf16 v[12:15], v[216:219], v[124:127], v[12:15]
    v_mfma_f32_16x16x32_bf16 v[12:15], v[72:75], v[176:179], v[12:15]
    ds_read_b128 v[84:87], v2 offset:24192
    v_mfma_f32_16x16x32_bf16 v[16:19], v[216:219], v[176:179], v[16:19]
    s_waitcnt lgkmcnt(2)
    v_mfma_f32_16x16x32_bf16 v[16:19], v[72:75], v[180:183], v[16:19]
    ds_read_b128 v[196:199], v2 offset:25408
    v_mfma_f32_16x16x32_bf16 v[12:15], v[208:211], v[180:183], v[12:15]
    v_mfma_f32_16x16x32_bf16 v[12:15], v[48:51], v[212:215], v[12:15]
    ds_read_b128 v[240:243], v2 offset:25536
    v_mfma_f32_16x16x32_bf16 v[16:19], v[208:211], v[212:215], v[16:19]
    s_waitcnt lgkmcnt(2)
    ds_read_b128 v[56:59], v2 offset:960
    v_mfma_f32_16x16x32_bf16 v[16:19], v[48:51], v[236:239], v[16:19]
    ds_read_b128 v[88:91], v2 offset:2176
    v_mfma_f32_16x16x32_bf16 v[12:15], v[76:79], v[236:239], v[12:15]
    v_mfma_f32_16x16x32_bf16 v[12:15], v[100:103], v[84:87], v[12:15]
    ds_read_b128 v[148:151], v2 offset:2304
    v_mfma_f32_16x16x32_bf16 v[16:19], v[76:79], v[84:87], v[16:19]
    s_waitcnt lgkmcnt(3)
    v_mfma_f32_16x16x32_bf16 v[16:19], v[100:103], v[196:199], v[16:19]
    ds_read_b128 v[124:127], v2 offset:2432
    v_mfma_f32_16x16x32_bf16 v[12:15], v[144:147], v[196:199], v[12:15]
    v_mfma_f32_16x16x32_bf16 v[16:19], v[144:147], v[240:243], v[16:19]
    s_waitcnt lgkmcnt(2)
    ds_read_b128 v[176:179], v2 offset:2560
    s_nop 0
    v_mfma_f32_16x16x32_bf16 v[28:31], v[220:223], v[56:59], v[28:31]
    s_nop 0
    s_nop 1
    v_mfma_f32_16x16x32_bf16 v[28:31], v[224:227], v[88:91], v[28:31]
    ds_read_b128 v[180:183], v2 offset:2688
    v_cvt_pk_bf16_f32 v12, v12, v13
    v_mfma_f32_16x16x32_bf16 v[32:35], v[220:223], v[88:91], v[32:35]
    s_waitcnt lgkmcnt(2)
    v_cvt_pk_bf16_f32 v13, v14, v15
    v_cvt_pk_bf16_f32 v14, v16, v17
    v_mfma_f32_16x16x32_bf16 v[32:35], v[224:227], v[148:151], v[32:35]
    ds_read_b128 v[212:215], v2 offset:2816
    v_cvt_pk_bf16_f32 v15, v18, v19
    v_mfma_f32_16x16x32_bf16 v[28:31], v[228:231], v[148:151], v[28:31]
    v_min_u32 v12, -2, v12
    v_min_u32 v13, -2, v13
    v_mfma_f32_16x16x32_bf16 v[28:31], v[232:235], v[124:127], v[28:31]
    ds_read_b128 v[236:239], v2 offset:2944
    v_min_u32 v14, -2, v14
    v_mfma_f32_16x16x32_bf16 v[32:35], v[228:231], v[124:127], v[32:35]
    s_waitcnt lgkmcnt(2)
    v_min_u32 v15, -2, v15
    v_mfma_f32_16x16x32_bf16 v[32:35], v[232:235], v[176:179], v[32:35]
    buffer_store_dwordx4 v[12:15], v3, s[28:31], s41 offen sc1
    ds_read_b128 v[84:87], v2 offset:3072
    v_and_b32 v24, 15, v0
    v_lshrrev_b32 v16, 4, v0
    v_mad_u32_u24 v17, v24, 17, v16
    v_mfma_f32_16x16x32_bf16 v[28:31], v[244:247], v[176:179], v[28:31]
    s_lshl_b32 s12, s10, 6
    s_add_u32 s12, s12, 149248
    v_lshl_add_u32 v17, v17, 4, s12
    v_mfma_f32_16x16x32_bf16 v[28:31], v[248:251], v[180:183], v[28:31]
    ds_read_b128 v[196:199], v2 offset:4288
    v_mad_u32_u24 v18, v16, 17, v24
    v_mfma_f32_16x16x32_bf16 v[32:35], v[244:247], v[180:183], v[32:35]
    s_waitcnt lgkmcnt(2)
    s_mul_i32 s12, s10, 1088
    s_add_u32 s12, s12, 144896
    v_mfma_f32_16x16x32_bf16 v[32:35], v[248:251], v[212:215], v[32:35]
    ds_read_b128 v[240:243], v2 offset:4416
    v_lshl_add_u32 v18, v18, 4, s12
    v_mfma_f32_16x16x32_bf16 v[28:31], v[36:39], v[212:215], v[28:31]
    v_mul_u32_u24 v16, 9, v16
    v_and_b32 v16, 17, v16
    v_mfma_f32_16x16x32_bf16 v[28:31], v[44:47], v[236:239], v[28:31]
    s_lshl2_add_u32 s12, s7, s10
    ds_read_b128 v[56:59], v2 offset:4544
    s_lshl3_add_u32 s12, s12, s4
    v_mfma_f32_16x16x32_bf16 v[32:35], v[36:39], v[236:239], v[32:35]
    s_waitcnt lgkmcnt(2)
    s_lshl4_add_u32 s12, s12, s6
    s_add_u32 s12, s12, 8
    v_mfma_f32_16x16x32_bf16 v[32:35], v[44:47], v[84:87], v[32:35]
    s_lshl_b32 s12, s12, 7
    ds_read_b128 v[220:223], v2 offset:4672
    v_lshl_add_u32 v19, v16, 6, v24
    v_mfma_f32_16x16x32_bf16 v[28:31], v[80:83], v[84:87], v[28:31]
    v_lshl_add_u32 v19, v19, 3, s12
    v_mfma_f32_16x16x32_bf16 v[28:31], v[52:55], v[196:199], v[28:31]
    ds_read_b128 v[88:91], v2 offset:4800
    v_mfma_f32_16x16x32_bf16 v[32:35], v[80:83], v[196:199], v[32:35]
    s_waitcnt lgkmcnt(2)
    ds_read_b128 v[224:227], v2 offset:4928
    v_mfma_f32_16x16x32_bf16 v[32:35], v[52:55], v[240:243], v[32:35]
    v_mfma_f32_16x16x32_bf16 v[28:31], v[60:63], v[240:243], v[28:31]
    ds_read_b128 v[148:151], v2 offset:21888
    v_mfma_f32_16x16x32_bf16 v[28:31], v[96:99], v[56:59], v[28:31]
    ds_read_b128 v[228:231], v2 offset:22016
    v_mfma_f32_16x16x32_bf16 v[32:35], v[60:63], v[56:59], v[32:35]
    s_waitcnt lgkmcnt(3)
    ds_read_b128 v[124:127], v2 offset:23232
    v_mfma_f32_16x16x32_bf16 v[32:35], v[96:99], v[220:223], v[32:35]
    s_barrier
    v_mfma_f32_16x16x32_bf16 v[28:31], v[68:71], v[220:223], v[28:31]
    v_mfma_f32_16x16x32_bf16 v[28:31], v[112:115], v[88:91], v[28:31]
    ds_read_b128 v[232:235], v2 offset:23360
    v_mfma_f32_16x16x32_bf16 v[32:35], v[68:71], v[88:91], v[32:35]
    s_waitcnt lgkmcnt(2)
    v_mfma_f32_16x16x32_bf16 v[32:35], v[112:115], v[224:227], v[32:35]
    ds_read_b128 v[176:179], v2 offset:23488
    v_mfma_f32_16x16x32_bf16 v[28:31], v[132:135], v[148:151], v[28:31]
    v_mfma_f32_16x16x32_bf16 v[28:31], v[92:95], v[228:231], v[28:31]
    ds_read_b128 v[244:247], v2 offset:23616
    v_mfma_f32_16x16x32_bf16 v[32:35], v[132:135], v[228:231], v[32:35]
    s_waitcnt lgkmcnt(2)
    v_mfma_f32_16x16x32_bf16 v[32:35], v[92:95], v[124:127], v[32:35]
    ds_read_b128 v[180:183], v2 offset:23744
    v_mfma_f32_16x16x32_bf16 v[28:31], v[160:163], v[124:127], v[28:31]
L_pad3_5:
    s_cbranch_execz L_main3
    v_mfma_f32_16x16x32_bf16 v[28:31], v[164:167], v[232:235], v[28:31]
    ds_read_b128 v[248:251], v2 offset:23872
    v_mfma_f32_16x16x32_bf16 v[32:35], v[160:163], v[232:235], v[32:35]
    s_waitcnt lgkmcnt(2)
    v_mfma_f32_16x16x32_bf16 v[32:35], v[164:167], v[176:179], v[32:35]
    ds_read_b128 v[212:215], v2 offset:24000
    v_mfma_f32_16x16x32_bf16 v[28:31], v[136:139], v[176:179], v[28:31]
    v_mfma_f32_16x16x32_bf16 v[28:31], v[140:143], v[244:247], v[28:31]
    ds_read_b128 v[36:39], v2 offset:24128
    v_mfma_f32_16x16x32_bf16 v[32:35], v[136:139], v[244:247], v[32:35]
    s_waitcnt lgkmcnt(2)
    v_mfma_f32_16x16x32_bf16 v[32:35], v[140:143], v[180:183], v[32:35]
    ds_read_b128 v[236:239], v2 offset:25344
    v_mfma_f32_16x16x32_bf16 v[28:31], v[168:171], v[180:183], v[28:31]
    v_mfma_f32_16x16x32_bf16 v[28:31], v[172:175], v[248:251], v[28:31]
    ds_read_b128 v[44:47], v2 offset:25472
    v_mfma_f32_16x16x32_bf16 v[32:35], v[168:171], v[248:251], v[32:35]
    s_waitcnt lgkmcnt(2)
    v_mfma_f32_16x16x32_bf16 v[32:35], v[172:175], v[212:215], v[32:35]
    ds_read_b128 v[84:87], v2 offset:25600
    v_mfma_f32_16x16x32_bf16 v[28:31], v[184:187], v[212:215], v[28:31]
    v_mfma_f32_16x16x32_bf16 v[28:31], v[188:191], v[36:39], v[28:31]
    ds_read_b128 v[80:83], v2 offset:25728
    v_mfma_f32_16x16x32_bf16 v[32:35], v[184:187], v[36:39], v[32:35]
    s_waitcnt lgkmcnt(2)
    ds_read_b128 v[196:199], v2 offset:25856
    v_mfma_f32_16x16x32_bf16 v[32:35], v[188:191], v[236:239], v[32:35]
    v_mfma_f32_16x16x32_bf16 v[28:31], v[200:203], v[236:239], v[28:31]
    ds_read_b128 v[52:55], v2 offset:25984
    v_mfma_f32_16x16x32_bf16 v[28:31], v[204:207], v[44:47], v[28:31]
    ds_read_b128 v[240:243], v2 offset:21952
    v_mfma_f32_16x16x32_bf16 v[32:35], v[200:203], v[44:47], v[32:35]
    s_waitcnt lgkmcnt(3)
    ds_read_b128 v[60:63], v2 offset:22080
    v_mfma_f32_16x16x32_bf16 v[32:35], v[204:207], v[84:87], v[32:35]
    buffer_load_dwordx4 v[56:59], v3, s[28:31], s44 offen sc1
    v_mfma_f32_16x16x32_bf16 v[28:31], v[252:255], v[84:87], v[28:31]
    v_mfma_f32_16x16x32_bf16 v[28:31], v[40:43], v[80:83], v[28:31]
    ds_read_b128 v[96:99], v2 offset:23296
    v_mfma_f32_16x16x32_bf16 v[32:35], v[252:255], v[80:83], v[32:35]
    s_waitcnt lgkmcnt(2)
    v_mfma_f32_16x16x32_bf16 v[32:35], v[40:43], v[196:199], v[32:35]
    ds_read_b128 v[220:223], v2 offset:23424
    v_mfma_f32_16x16x32_bf16 v[28:31], v[64:67], v[196:199], v[28:31]
    v_mfma_f32_16x16x32_bf16 v[32:35], v[64:67], v[52:55], v[32:35]
    ds_read_b128 v[68:71], v2 offset:23552
    v_mfma_f32_16x16x32_bf16 v[28:31], v[116:119], v[240:243], v[28:31]
    s_waitcnt lgkmcnt(2)
    v_mfma_f32_16x16x32_bf16 v[28:31], v[128:131], v[60:63], v[28:31]
    ds_read_b128 v[88:91], v2 offset:23680
    v_mfma_f32_16x16x32_bf16 v[32:35], v[116:119], v[60:63], v[32:35]
    v_mfma_f32_16x16x32_bf16 v[32:35], v[128:131], v[96:99], v[32:35]
    ds_read_b128 v[112:115], v2 offset:23808
    v_mfma_f32_16x16x32_bf16 v[28:31], v[104:107], v[96:99], v[28:31]
    s_waitcnt lgkmcnt(2)
    v_mfma_f32_16x16x32_bf16 v[28:31], v[108:111], v[220:223], v[28:31]
    ds_read_b128 v[224:227], v2 offset:23936
    v_mfma_f32_16x16x32_bf16 v[32:35], v[104:107], v[220:223], v[32:35]
    v_mfma_f32_16x16x32_bf16 v[32:35], v[108:111], v[68:71], v[32:35]
    ds_read_b128 v[148:151], v2 offset:24064
    v_mfma_f32_16x16x32_bf16 v[28:31], v[120:123], v[68:71], v[28:31]
    s_waitcnt lgkmcnt(2)
    v_mfma_f32_16x16x32_bf16 v[28:31], v[152:155], v[88:91], v[28:31]
    ds_read_b128 v[132:135], v2 offset:24192
    v_mfma_f32_16x16x32_bf16 v[32:35], v[120:123], v[88:91], v[32:35]
    v_mfma_f32_16x16x32_bf16 v[32:35], v[152:155], v[112:115], v[32:35]
    ds_read_b128 v[228:231], v2 offset:25408
    v_mfma_f32_16x16x32_bf16 v[28:31], v[156:159], v[112:115], v[28:31]
    s_waitcnt lgkmcnt(2)
    v_mfma_f32_16x16x32_bf16 v[28:31], v[192:195], v[224:227], v[28:31]
    ds_read_b128 v[92:95], v2 offset:25536
    v_mfma_f32_16x16x32_bf16 v[32:35], v[156:159], v[224:227], v[32:35]
    v_mfma_f32_16x16x32_bf16 v[32:35], v[192:195], v[148:151], v[32:35]
    ds_read_b128 v[124:127], v2 offset:25664
    v_mfma_f32_16x16x32_bf16 v[28:31], v[216:219], v[148:151], v[28:31]
    s_waitcnt lgkmcnt(2)
    v_mfma_f32_16x16x32_bf16 v[28:31], v[72:75], v[132:135], v[28:31]
    ds_read_b128 v[160:163], v2 offset:25792
    v_mfma_f32_16x16x32_bf16 v[32:35], v[216:219], v[132:135], v[32:35]
    v_mfma_f32_16x16x32_bf16 v[32:35], v[72:75], v[228:231], v[32:35]
    ds_read_b128 v[232:235], v2 offset:25920
    v_mfma_f32_16x16x32_bf16 v[28:31], v[208:211], v[228:231], v[28:31]
    s_waitcnt lgkmcnt(2)
    v_mfma_f32_16x16x32_bf16 v[28:31], v[48:51], v[92:95], v[28:31]
    ds_read_b128 v[164:167], v2 offset:26048
    v_mfma_f32_16x16x32_bf16 v[32:35], v[208:211], v[92:95], v[32:35]
    v_mfma_f32_16x16x32_bf16 v[32:35], v[48:51], v[124:127], v[32:35]
    v_mfma_f32_16x16x32_bf16 v[28:31], v[76:79], v[124:127], v[28:31]
    s_waitcnt lgkmcnt(1)
    v_mfma_f32_16x16x32_bf16 v[28:31], v[100:103], v[160:163], v[28:31]
    v_mfma_f32_16x16x32_bf16 v[32:35], v[76:79], v[160:163], v[32:35]
    v_mfma_f32_16x16x32_bf16 v[32:35], v[100:103], v[232:235], v[32:35]
    v_mfma_f32_16x16x32_bf16 v[28:31], v[144:147], v[232:235], v[28:31]
    s_waitcnt lgkmcnt(0)
    s_waitcnt vmcnt(0)
    v_max3_u32 v176, v56, v57, v58
    v_mfma_f32_16x16x32_bf16 v[32:35], v[144:147], v[164:167], v[32:35]
    v_max_u32 v176, v176, v59
    v_cmp_eq_u32 vcc, -1, v176
    s_cbranch_vccnz L_again3
L_fin3:
    v_lshlrev_b32 v176, 16, v56
    v_and_b32 v177, s38, v56
    v_lshlrev_b32 v178, 16, v57
    v_and_b32 v179, s38, v57
    v_lshlrev_b32 v136, 16, v58
    v_and_b32 v137, s38, v58
    v_lshlrev_b32 v138, 16, v59
    v_and_b32 v139, s38, v59
    v_pk_add_f32 v[176:177], v[176:177], v[28:29]
    v_pk_add_f32 v[178:179], v[178:179], v[30:31]
    v_pk_mul_f32 v[176:177], v[176:177], s[36:37]
    v_pk_mul_f32 v[178:179], v[178:179], s[36:37]
    v_exp_f32 v176, v176
    v_exp_f32 v177, v177
    v_exp_f32 v178, v178
    v_exp_f32 v179, v179
    v_pk_add_f32 v[136:137], v[136:137], v[32:33]
    v_pk_add_f32 v[138:139], v[138:139], v[34:35]
    v_pk_mul_f32 v[136:137], v[136:137], s[36:37]
    v_pk_mul_f32 v[138:139], v[138:139], s[36:37]
    v_pk_add_f32 v[176:177], v[176:177], 1.0 op_sel_hi:[1,0]
    v_pk_add_f32 v[178:179], v[178:179], 1.0 op_sel_hi:[1,0]
    v_rcp_f32 v176, v176
    v_rcp_f32 v177, v177
    v_rcp_f32 v178, v178
    v_rcp_f32 v179, v179
    v_exp_f32 v136, v136
    v_exp_f32 v137, v137
    v_exp_f32 v138, v138
    v_exp_f32 v139, v139
    ds_write_b128 v17, v[176:179] offset:0
    v_pk_add_f32 v[136:137], v[136:137], 1.0 op_sel_hi:[1,0]
    v_pk_add_f32 v[138:139], v[138:139], 1.0 op_sel_hi:[1,0]
    v_rcp_f32 v136, v136
    v_rcp_f32 v137, v137
    v_rcp_f32 v138, v138
    v_rcp_f32 v139, v139
    s_nop 0
    ds_write_b128 v17, v[136:139] offset:4352
    s_waitcnt lgkmcnt(0)
    s_barrier
    ds_read_b128 v[244:247], v18
    ds_read_b128 v[140:143], v18 offset:8704
    s_waitcnt lgkmcnt(0)
    v_pk_mul_f32 v[244:245], v[244:245], v[140:141]
    v_pk_mul_f32 v[246:247], v[246:247], v[142:143]
    v_pk_fma_f32 v[244:245], v[244:245], -2.0, v[140:141] op_sel_hi:[1,0,1]
    v_pk_fma_f32 v[246:247], v[246:247], -2.0, v[142:143] op_sel_hi:[1,0,1]
    v_cvt_pk_bf16_f32 v244, v244, v245
    v_cvt_pk_bf16_f32 v245, v246, v247
    buffer_store_dwordx2 v[244:245], v19, s[24:27], 0 offen
    s_endpgm
L_again3:
    s_add_u32 s13, s13, 1
    s_cmp_ge_u32 s13, 200000
    s_cbranch_scc1 L_fin3
    buffer_load_dwordx4 v[56:59], v3, s[28:31], s44 offen sc1
    s_waitcnt vmcnt(0)
    v_max3_u32 v176, v56, v57, v58
    v_max_u32 v176, v176, v59
    v_cmp_eq_u32 vcc, -1, v176
    s_cbranch_vccnz L_again3
    s_branch L_fin3
.p2align 12
.section .rodata,"a"
.p2align 6
.amdhsa_kernel standalone__autoregressive_conv_wavernn__speech_kernel
  .amdhsa_next_free_vgpr 256
  .amdhsa_next_free_sgpr 102
  .amdhsa_accum_offset 256
  .amdhsa_group_segment_fixed_size 0
  .amdhsa_kernarg_size 40
  .amdhsa_user_sgpr_count 2
  .amdhsa_user_sgpr_kernarg_segment_ptr 1
  .amdhsa_system_sgpr_workgroup_id_x 1
.end_amdhsa_kernel
```
